```python
import torch

def _softmax(x, axis=-1):
    return torch.softmax(x, dim=axis)
def _gelu(x):
    return torch.nn.functional.gelu(x, approximate="tanh")
def _silu(x):
    return torch.nn.functional.silu(x)
def _sigmoid(x):
    return torch.sigmoid(x)
def _layernorm(x, axis=-1, eps=1e-5):
    m = x.mean(dim=axis, keepdim=True)
    v = x.var(dim=axis, keepdim=True, unbiased=False)
    return (x - m) / torch.sqrt(v + eps)
def _scatter_add(tgt, idx, src, axis=0):
    return tgt.clone().index_add_(axis, idx, src)
def _segment_sum(src, seg, n):
    out = torch.zeros((n,) + src.shape[1:], dtype=src.dtype)
    return out.index_add_(0, seg, src)
def _pad(x, pw):
    flat = tuple(v for pair in reversed(pw) for v in pair)
    return torch.nn.functional.pad(x, flat)

kernel_name = 'concat_heads__softmax_full_mha__softmax_full_mha__prompt'

def setup_inputs():

    _w = (lambda a: (lambda t: t.to(torch.bfloat16) if t.is_floating_point() else t)(torch.as_tensor(a)))
    def _A_setup():
        B, S, D = 1, 2048, 448
        return {
            "x": _w((lambda *s: torch.randn(*s, dtype=torch.bfloat16) * 0.2)(B, S, D)),
            "wqkv": _w((lambda *s: torch.randn(*s, dtype=torch.bfloat16) * 0.2)(D, 3 * D)),
            "wo": _w((lambda *s: torch.randn(*s, dtype=torch.bfloat16) * 0.05)(D, D)),
        }
    _A_in = _A_setup()

    def _B_setup():
        B, S, D = 1, 2048, 448
        return {
            "x": _w((lambda *s: torch.randn(*s, dtype=torch.bfloat16) * 0.2)(B, S, D)),
            "wqkv": _w((lambda *s: torch.randn(*s, dtype=torch.bfloat16) * 0.2)(D, 3 * D)),
            "wo": _w((lambda *s: torch.randn(*s, dtype=torch.bfloat16) * 0.05)(D, D)),
        }
    _B_in = _B_setup()

    return {
        "A_x": _A_in["x"],
        "A_wqkv": _A_in["wqkv"],
        "A_wo": _A_in["wo"],
        "B_x": _B_in["x"],
        "B_wqkv": _B_in["wqkv"],
        "B_wo": _B_in["wo"],
    }

def reference(A_x, A_wqkv, A_wo, B_x, B_wqkv, B_wo):
    def _A_ref(x, wqkv, wo):
        B, S, D = x.shape
        H = 16; Dh = D // H
        qkv = (lambda x, *d: x.permute(*d))((x @ wqkv).reshape(B, S, 3, H, Dh), 2, 0, 3, 1, 4)
        q, k, v = qkv[0], qkv[1], qkv[2]
        scale = Dh ** -0.5
        scores = torch.einsum("bhqd,bhkd->bhqk", q, k) * scale
        p = _softmax(scores, axis=-1)
        o = torch.einsum("bhqk,bhkd->bhqd", p, v)
        return (lambda x, *d: x.permute(*d))(o, 0, 2, 1, 3).reshape(B, S, D) @ wo

    def _B_ref(x, wqkv, wo):
        B, S, D = x.shape
        H = 16; Dh = D // H
        qkv = (lambda x, *d: x.permute(*d))((x @ wqkv).reshape(B, S, 3, H, Dh), 2, 0, 3, 1, 4)
        q, k, v = qkv[0], qkv[1], qkv[2]
        scale = Dh ** -0.5
        scores = torch.einsum("bhqd,bhkd->bhqk", q, k) * scale
        p = _softmax(scores, axis=-1)
        o = torch.einsum("bhqk,bhkd->bhqd", p, v)
        return (lambda x, *d: x.permute(*d))(o, 0, 2, 1, 3).reshape(B, S, D) @ wo

    a = _A_ref(A_x, A_wqkv, A_wo)
    b = _B_ref(B_x, B_wqkv, B_wo)
    return torch.concatenate([a, b], axis=-1)
```

```asm
; @launch grid=(256,1,1) block=(512,1,1) lds=163840
.amdgcn_target "amdgcn-amd-amdhsa--gfx950"
.text
.globl concat_heads__softmax_full_mha__softmax_full_mha__prompt_kernel
.p2align 8
.type concat_heads__softmax_full_mha__softmax_full_mha__prompt_kernel,@function
concat_heads__softmax_full_mha__softmax_full_mha__prompt_kernel:
    s_cmp_ge_u32 s2, 256
    s_cbranch_scc1 L_end
    s_load_dwordx16 s[8:23], s[0:1], 0
    s_load_dwordx2 s[24:25], s[0:1], 64
    v_lshrrev_b32 v5, 6, v0
    v_and_b32 v1, 63, v0
    v_readfirstlane_b32 s48, v5
    v_lshlrev_b32 v3, 4, v1
    s_and_b32 s60, s2, 7
    s_lshr_b32 s61, s2, 3
    s_and_b32 s51, s61, 7
    s_lshr_b32 s61, s61, 3
    s_lshl_b32 s60, s60, 2
    s_add_u32 s74, s60, s61
    s_lshr_b32 s49, s74, 4
    s_and_b32 s50, s74, 15
    s_lshr_b32 s78, s48, 2
    s_mul_i32 s6, s50, 7
    s_lshr_b32 s6, s6, 4
    s_add_u32 s6, s6, s51
    s_mul_i32 s61, s6, 37
    s_lshr_b32 s61, s61, 8
    s_mul_i32 s61, s61, 7
    s_sub_u32 s6, s6, s61
    s_and_b32 s60, s2, 0xf8
    s_add_u32 s60, s60, s48
    s_mul_i32 s60, s60, 192
    s_getpc_b64 s[82:83]
L_nopf:
    v_and_b32 v9, 0x80, v3
    v_add_u32 v9, s60, v9
    v_min_u32 v9, L_slow-L_nopf, v9
    global_load_dword v10, v9, s[82:83]
    s_lshr_b32 s100, 0x240, s50
    s_and_b32 s100, s100, 1
    s_cmp_gt_u32 s78, s100
    s_cbranch_scc1 L_wfirst
    s_cmp_gt_u32 s50, 7
    s_cselect_b32 s67, 1, 0
    s_cselect_b32 s60, 16, 1
    s_cselect_b32 s61, 1, 2
    s_cselect_b32 s62, 2, 8
    s_cselect_b32 s63, 8, 16
    v_bfe_u32 v5, v1, 3, 1
    v_mul_u32_u24 v5, s60, v5
    v_bfe_u32 v6, v1, 4, 1
    v_mad_u32_u24 v5, v6, s61, v5
    v_lshrrev_b32 v6, 5, v1
    v_lshl_add_u32 v5, v6, 2, v5
    v_mul_u32_u24 v8, 896, v5
    s_mul_i32 s62, s62, 896
    s_mul_i32 s63, s63, 896
    s_sub_u32 s62, s62, 1024
    s_sub_u32 s63, s63, 2048
    v_lshrrev_b32 v6, 4, v1
    v_and_b32 v7, 7, v1
    v_xor_b32 v6, v6, v7
    v_lshl_add_u32 v232, v6, 4, v8
    v_xor_b32 v6, 4, v6
    v_lshl_add_u32 v6, v6, 4, v8
    v_add_u32 v233, s62, v6
    v_add_u32 v234, s63, v232
    v_add_u32 v235, s63, v233
    s_lshl_b32 s60, s51, 3
    s_add_u32 s60, s60, s48
    s_mul_i32 s55, s60, 28672
    s_lshl_b32 s57, s48, 12
    s_lshl_b32 s60, s78, 14
    s_add_u32 s69, s57, s60
    s_add_u32 s69, s69, 32768
    s_lshl_b32 s54, s6, 7
    s_mov_b32 s30, 1835008
    s_mov_b32 s31, 0x20000
    s_cmp_eq_u32 s49, 0
    s_waitcnt lgkmcnt(0)
    s_cselect_b32 s28, s8, s14
    s_cselect_b32 s29, s9, s15
    s_cselect_b32 s32, s10, s16
    s_cselect_b32 s33, s11, s17
    s_cselect_b32 s40, s12, s18
    s_cselect_b32 s41, s13, s19
    s_add_u32 m0, s69, 0
    s_add_u32 s93, s54, s55
    buffer_load_dwordx4 v232, s[28:31], s93 offen lds
    s_add_u32 s54, s54, 128
    s_cmp_eq_u32 s54, 896
    s_cselect_b32 s54, 0, s54
    buffer_load_dwordx4 v233, s[28:31], s93 offen offset:1024 lds
    buffer_load_dwordx4 v234, s[28:31], s93 offen offset:2048 lds
    buffer_load_dwordx4 v235, s[28:31], s93 offen offset:3072 lds
    s_add_u32 m0, s69, 16384
    s_add_u32 s93, s54, s55
    buffer_load_dwordx4 v232, s[28:31], s93 offen lds
    s_add_u32 s54, s54, 128
    s_cmp_eq_u32 s54, 896
    s_cselect_b32 s54, 0, s54
    buffer_load_dwordx4 v233, s[28:31], s93 offen offset:1024 lds
    buffer_load_dwordx4 v234, s[28:31], s93 offen offset:2048 lds
    buffer_load_dwordx4 v235, s[28:31], s93 offen offset:3072 lds
    s_mov_b32 s34, 1204224
    s_mov_b32 s35, 0x20000
    s_cmp_gt_u32 s50, 6
    s_subb_u32 s66, s50, 0
    s_cmp_gt_u32 s50, 9
    s_subb_u32 s66, s66, 0
    s_lshl_b32 s56, s66, 7
    s_cmp_ge_u32 s66, 7
    s_cselect_b32 s60, 7, 0
    s_sub_u32 s66, s66, s60
    s_and_b32 s61, s48, 3
    s_mul_i32 s60, s61, 43008
    s_add_u32 s56, s56, s60
    s_add_u32 s56, s56, 896
    s_mul_i32 s59, s6, 172032
    s_lshl_b32 s58, s61, 11
    s_add_u32 s58, s58, 98304
    v_lshrrev_b32 v5, 3, v1
    v_mul_u32_u24 v5, 2688, v5
    v_bfe_u32 v6, v1, 4, 1
    v_lshlrev_b32 v6, 2, v6
    v_and_b32 v7, 7, v1
    v_xor_b32 v6, v6, v7
    v_lshl_add_u32 v236, v6, 4, v5
    v_add_u32 v237, 20480, v236
    s_branch L_now
L_wfirst:
    s_mov_b32 s34, 1204224
    s_mov_b32 s35, 0x20000
    s_cmp_gt_u32 s50, 6
    s_subb_u32 s66, s50, 0
    s_cmp_gt_u32 s50, 9
    s_subb_u32 s66, s66, 0
    s_lshl_b32 s56, s66, 7
    s_cmp_ge_u32 s66, 7
    s_cselect_b32 s60, 7, 0
    s_sub_u32 s66, s66, s60
    s_and_b32 s61, s48, 3
    s_mul_i32 s60, s61, 43008
    s_add_u32 s56, s56, s60
    s_add_u32 s56, s56, 896
    s_mul_i32 s59, s6, 172032
    s_lshl_b32 s58, s61, 11
    s_add_u32 s58, s58, 98304
    v_lshrrev_b32 v5, 3, v1
    v_mul_u32_u24 v5, 2688, v5
    v_bfe_u32 v6, v1, 4, 1
    v_lshlrev_b32 v6, 2, v6
    v_and_b32 v7, 7, v1
    v_xor_b32 v6, v6, v7
    v_lshl_add_u32 v236, v6, 4, v5
    v_add_u32 v237, 20480, v236
    s_cmp_eq_u32 s49, 0
    s_waitcnt lgkmcnt(0)
    s_cselect_b32 s28, s8, s14
    s_cselect_b32 s29, s9, s15
    s_cselect_b32 s32, s10, s16
    s_cselect_b32 s33, s11, s17
    s_cselect_b32 s40, s12, s18
    s_cselect_b32 s41, s13, s19
    s_add_u32 m0, s58, 0
    s_add_u32 s94, s59, s56
    buffer_load_dwordx4 v236, s[32:35], s94 offen lds
    s_add_u32 s59, s59, 172032
    s_cmp_eq_u32 s59, 1204224
    s_cselect_b32 s59, 0, s59
    buffer_load_dwordx4 v237, s[32:35], s94 offen offset:1024 lds
    s_add_u32 m0, s58, 8192
    s_add_u32 s94, s59, s56
    buffer_load_dwordx4 v236, s[32:35], s94 offen lds
    s_add_u32 s59, s59, 172032
    s_cmp_eq_u32 s59, 1204224
    s_cselect_b32 s59, 0, s59
    buffer_load_dwordx4 v237, s[32:35], s94 offen offset:1024 lds
    s_add_u32 m0, s58, 16384
    s_add_u32 s94, s59, s56
    buffer_load_dwordx4 v236, s[32:35], s94 offen lds
    s_add_u32 s59, s59, 172032
    s_cmp_eq_u32 s59, 1204224
    s_cselect_b32 s59, 0, s59
    buffer_load_dwordx4 v237, s[32:35], s94 offen offset:1024 lds
    s_add_u32 m0, s58, 24576
    s_add_u32 s94, s59, s56
    buffer_load_dwordx4 v236, s[32:35], s94 offen lds
    s_add_u32 s59, s59, 172032
    s_cmp_eq_u32 s59, 1204224
    s_cselect_b32 s59, 0, s59
    buffer_load_dwordx4 v237, s[32:35], s94 offen offset:1024 lds
    s_cmp_gt_u32 s50, 7
    s_cselect_b32 s67, 1, 0
    s_cselect_b32 s60, 16, 1
    s_cselect_b32 s61, 1, 2
    s_cselect_b32 s62, 2, 8
    s_cselect_b32 s63, 8, 16
    v_bfe_u32 v5, v1, 3, 1
    v_mul_u32_u24 v5, s60, v5
    v_bfe_u32 v6, v1, 4, 1
    v_mad_u32_u24 v5, v6, s61, v5
    v_lshrrev_b32 v6, 5, v1
    v_lshl_add_u32 v5, v6, 2, v5
    v_mul_u32_u24 v8, 896, v5
    s_mul_i32 s62, s62, 896
    s_mul_i32 s63, s63, 896
    s_sub_u32 s62, s62, 1024
    s_sub_u32 s63, s63, 2048
    v_lshrrev_b32 v6, 4, v1
    v_and_b32 v7, 7, v1
    v_xor_b32 v6, v6, v7
    v_lshl_add_u32 v232, v6, 4, v8
    v_xor_b32 v6, 4, v6
    v_lshl_add_u32 v6, v6, 4, v8
    v_add_u32 v233, s62, v6
    v_add_u32 v234, s63, v232
    v_add_u32 v235, s63, v233
    s_lshl_b32 s60, s51, 3
    s_add_u32 s60, s60, s48
    s_mul_i32 s55, s60, 28672
    s_lshl_b32 s57, s48, 12
    s_lshl_b32 s60, s78, 14
    s_add_u32 s69, s57, s60
    s_add_u32 s69, s69, 32768
    s_lshl_b32 s54, s6, 7
    s_mov_b32 s30, 1835008
    s_mov_b32 s31, 0x20000
L_now:
    s_lshl_b32 s60, s49, 8
    s_add_u32 s60, s60, 65536
    s_load_dword s53, s[24:25], s60
    v_lshrrev_b32 v7, 5, v1
    v_and_b32 v5, 31, v1
    v_bfe_u32 v6, v1, 1, 3
    v_xor_b32 v6, v6, v7
    v_lshlrev_b32 v5, 7, v5
    v_add_u32 v5, s69, v5
    v_xor_b32 v8, 0, v6
    v_lshl_add_u32 v239, v8, 4, v5
    v_xor_b32 v8, 2, v6
    v_lshl_add_u32 v240, v8, 4, v5
    v_xor_b32 v8, 4, v6
    v_lshl_add_u32 v241, v8, 4, v5
    v_xor_b32 v8, 6, v6
    v_lshl_add_u32 v242, v8, 4, v5
    v_bfe_u32 v6, v1, 2, 2
    v_lshl_add_u32 v5, v7, 3, v6
    v_bfe_u32 v8, v1, 4, 1
    v_and_b32 v9, 3, v1
    v_lshlrev_b32 v9, 3, v9
    v_lshl_add_u32 v9, v8, 5, v9
    v_lshl_add_u32 v245, v5, 6, v9
    v_lshl_add_u32 v9, v5, 7, v9
    v_lshrrev_b32 v6, 1, v6
    v_lshl_add_u32 v9, v6, 6, v9
    v_add_u32 v243, 98304, v9
    v_xor_b32 v244, 64, v243
    s_and_b32 s60, s50, 1
    s_lshl_b32 s60, s60, 3
    s_add_u32 s60, s60, 0
    v_add_u32 v245, s60, v245
    s_mul_i32 s70, s50, 56
    s_and_b32 s70, s70, 0xfffffff0
    s_and_b32 s60, s48, 3
    s_lshl_b32 s7, s60, 10
    s_mul_i32 s60, s60, 43008
    s_add_u32 s70, s70, s60
    s_mul_i32 s3, s6, 172032
    v_lshrrev_b32 v5, 2, v1
    v_mul_u32_u24 v5, 2688, v5
    v_and_b32 v6, 3, v1
    v_lshl_add_u32 v238, v6, 4, v5
    s_mov_b32 s36, s24
    s_mov_b32 s37, s25
    s_mov_b32 s38, 16777216
    s_mov_b32 s39, 0x20000
    s_lshl_b32 s92, s49, 22
    s_lshl_b32 s72, s51, 15
    s_add_u32 s72, s72, s57
    s_mul_i32 s60, s78, 0
    s_add_u32 s72, s72, s60
    s_add_u32 s92, s92, s72
    s_add_u32 s92, s92, 1048576
    s_and_b32 s60, s48, 3
    s_lshl_b32 s60, s60, 1
    s_lshl_b32 s61, s49, 3
    s_add_u32 s61, s61, s51
    s_lshl_b32 s61, s61, 3
    s_add_u32 s60, s60, s61
    s_lshl_b32 s60, s60, 4
    s_add_u32 s60, s60, s50
    s_lshl_b32 s97, s60, 11
    s_add_u32 s97, s97, 9437184
    s_lshl_b32 s76, s78, 15
    s_add_u32 s76, s76, s97
    v_mov_b32 v252, 16256
    v_mov_b32 v253, 0
    v_mov_b32 v254, 16256
    v_mov_b32 v255, 0
    s_add_u32 s79, s61, s48
    s_mul_i32 s79, s79, 2048
    s_lshl_b32 s60, s50, 7
    s_add_u32 s79, s79, s60
    s_add_u32 s79, s79, 13631488
    s_waitcnt lgkmcnt(0)
    s_mul_i32 s52, s53, 0x9e3779b1
    s_add_u32 s52, s52, 0x7f4a7c15
    v_mov_b32 v31, s52
    s_cmp_eq_u32 s78, 0
    s_cbranch_scc1 L_old
    s_cmp_eq_u32 s100, 1
    s_cbranch_scc1 L_yN
    s_waitcnt vmcnt(4)
    s_barrier
    s_add_u32 m0, s58, 32768
    s_add_u32 s94, s59, s56
    buffer_load_dwordx4 v236, s[32:35], s94 offen lds
    s_add_u32 s59, s59, 172032
    s_cmp_eq_u32 s59, 1204224
    s_cselect_b32 s59, 0, s59
    s_lshl_b32 s5, s49, 6
    s_and_b32 s61, s48, 3
    s_add_u32 s5, s5, s61
    s_mul_i32 s5, s5, 2048
    s_add_u32 s5, s5, 13631488
    s_lshl_b32 s60, s50, 1
    s_add_u32 s60, s60, s78
    s_and_b32 s60, s60, 7
    s_lshl_b32 s72, s60, 15
    s_lshl_b32 s61, s61, 12
    s_add_u32 s72, s72, s61
    v_bfe_u32 v8, v1, 2, 2
    v_lshl_add_u32 v8, v8, 1, s60
    v_lshrrev_b32 v6, 5, v1
    v_add_u32 v8, v8, v6
    buffer_load_dwordx4 v237, s[32:35], s94 offen offset:1024 lds
    v_and_b32 v8, 7, v8
    v_bfe_u32 v6, v1, 4, 1
    v_lshl_add_u32 v8, v8, 1, v6
    v_mul_u32_u24 v8, 8192, v8
    s_mul_i32 s60, s50, 28
    s_add_u32 s61, s60, 27
    s_lshr_b32 s60, s60, 6
    s_lshr_b32 s61, s61, 6
    s_sub_u32 s61, s61, s60
    v_and_b32 v5, 1, v1
    v_mul_u32_u24 v5, s61, v5
    v_add_u32 v5, s60, v5
    v_bfe_u32 v6, v1, 1, 1
    v_mad_u32_u24 v5, v6, 7, v5
    v_add_u32 v9, 10, v5
    s_add_u32 m0, s58, 40960
    s_add_u32 s94, s59, s56
    buffer_load_dwordx4 v236, s[32:35], s94 offen lds
    s_add_u32 s59, s59, 172032
    s_cmp_eq_u32 s59, 1204224
    s_cselect_b32 s59, 0, s59
    v_lshrrev_b32 v9, 4, v9
    v_lshrrev_b32 v7, 3, v5
    v_add3_u32 v5, v5, v9, v7
    s_sub_u32 s62, s61, 1
    s_and_b32 s62, s62, 0xaaaaaaaa
    s_mov_b32 s63, s62
    v_mad_u32_u24 v6, v6, 3, 6
    v_cndmask_b32 v5, v5, v6, s[62:63]
    v_lshl_add_u32 v17, v5, 7, v8
    s_lshl_b32 s68, s74, 18
    s_add_u32 s68, s68, 1048576
    s_mov_b32 s84, s78
    s_mov_b32 s64, -1
    s_mov_b32 s65, 0
    s_mov_b32 s90, 0x3e8b97f6
    buffer_load_dwordx4 v237, s[32:35], s94 offen offset:1024 lds
    s_mov_b32 s91, 0x3e8b97f6
    s_and_b32 s61, s48, 3
    v_mov_b32 v4, 0xdddddddd
    s_or_b32 s62, s61, 1
    s_add_u32 s60, s61, s62
    s_lshl_b32 s60, s60, 11
    s_add_u32 s60, s60, 65536
    s_lshl_b32 s62, s61, 11
    s_add_u32 s62, s62, 155648
    s_sub_u32 s60, s60, s62
    s_mul_i32 s60, s60, s78
    s_add_u32 s60, s60, s62
    v_and_b32 v5, 1, v1
    v_lshlrev_b32 v5, 4, v5
    v_bfe_u32 v6, v1, 4, 1
    s_add_u32 m0, s58, 49152
    s_add_u32 s94, s59, s56
    buffer_load_dwordx4 v236, s[32:35], s94 offen lds
    s_add_u32 s59, s59, 172032
    s_cmp_eq_u32 s59, 1204224
    s_cselect_b32 s59, 0, s59
    v_lshl_add_u32 v5, v6, 3, v5
    v_bfe_u32 v6, v1, 3, 1
    v_lshl_add_u32 v5, v6, 1, v5
    v_bfe_u32 v6, v1, 1, 1
    v_add_u32 v5, v5, v6
    v_and_b32 v6, 0x24, v1
    v_add_u32 v5, v5, v6
    v_sub_u32 v5, v5, v1
    v_mul_lo_u32 v5, v5, s67
    v_add_u32 v5, v5, v1
    v_lshl_add_u32 v12, v5, 4, s60
    s_lshr_b32 s63, s61, 1
    s_and_b32 s62, s61, 1
    s_add_u32 s60, s63, 12
    s_lshl_b32 s62, s62, s60
    buffer_load_dwordx4 v237, s[32:35], s94 offen offset:1024 lds
    s_mul_i32 s63, s63, 4294879232
    s_add_u32 s62, s62, s63
    s_add_u32 s62, s62, 155648
    s_lshl_b32 s60, s78, 11
    s_sub_u32 s63, s62, s60
    s_add_u32 s62, s62, s60
    v_add_u32 v13, s63, v3
    v_add_u32 v29, s62, v3
    s_lshl_b32 s60, s78, 14
    v_add_u32 v14, s60, v3
    v_add_u32 v15, 0x10000, v14
    v_lshl_add_u32 v19, v1, 3, s60
    s_mov_b32 s42, 401408
    s_mov_b32 s43, 0x20000
    s_mov_b32 s44, s20
    s_add_u32 m0, s69, 0
    s_add_u32 s93, s54, s55
    buffer_load_dwordx4 v232, s[28:31], s93 offen lds
    s_add_u32 s54, s54, 128
    s_cmp_eq_u32 s54, 896
    s_cselect_b32 s54, 0, s54
    s_mov_b32 s45, s21
    s_mov_b32 s46, 3670016
    s_mov_b32 s47, 0x20000
    s_mov_b32 s89, 1006632960
    s_and_b32 s77, s50, 3
    s_mul_i32 s77, s77, 224
    s_lshl_b32 s61, s49, 3
    s_add_u32 s61, s61, s51
    s_lshl_b32 s61, s61, 3
    s_lshr_b32 s60, s50, 2
    s_bfe_u32 s62, s48, 0x10001
    s_lshl_b32 s87, s62, 2
    s_add_u32 s87, s87, s60
    s_add_u32 s87, s87, s61
    s_mul_i32 s87, s87, 2048
    buffer_load_dwordx4 v233, s[28:31], s93 offen offset:1024 lds
    s_add_u32 s87, s87, 13631552
    s_lshl_b32 s63, s60, 1
    s_add_u32 s63, s63, s62
    s_add_u32 s63, s63, s61
    s_lshl_b32 s86, s63, 15
    s_add_u32 s86, s86, 9437184
    s_and_b32 s63, s48, 1
    s_lshl_b32 s63, s63, 8
    s_add_u32 s86, s86, s63
    s_lshl_b32 s63, s78, 11
    s_add_u32 s86, s86, s63
    s_lshl_b32 s61, s51, 2
    s_add_u32 s60, s60, s61
    s_lshl_b32 s60, s60, 2
    s_and_b32 s61, s48, 3
    buffer_load_dwordx4 v234, s[28:31], s93 offen offset:2048 lds
    s_add_u32 s60, s60, s61
    s_mul_i32 s88, s60, 28672
    s_mul_i32 s60, s49, 896
    s_add_u32 s88, s88, s60
    s_add_u32 s88, s88, s77
    v_and_b32 v7, 7, v1
    s_add_u32 s60, s61, 5
    s_lshl_b32 s60, s60, 13
    s_and_b32 s60, s60, 0xffff
    v_add_u32 v24, s60, v3
    s_lshl_b32 s62, s61, 2
    s_add_u32 s62, s62, 161280
    v_mov_b32 v25, s62
    s_mul_i32 s62, s61, 3072
    s_add_u32 s62, s62, 16384
    buffer_load_dwordx4 v235, s[28:31], s93 offen offset:3072 lds
    v_add_u32 v23, s62, v3
    v_lshrrev_b32 v6, 3, v1
    s_lshl_b32 s62, s78, 11
    s_add_u32 s60, s60, s62
    s_add_u32 s60, s60, 4096
    v_xor_b32 v8, v6, v7
    v_lshlrev_b32 v8, 4, v8
    v_lshl_add_u32 v8, v6, 7, v8
    v_add_u32 v27, s60, v8
    s_and_b32 s9, s50, 3
    s_lshl_b32 s9, s9, 1
    s_lshl_b32 s62, s78, 3
    s_add_u32 s62, s62, s9
    v_add_u32 v9, s62, v7
    v_subrev_u32 v8, 14, v9
    s_waitcnt vmcnt(4)
    s_barrier
    s_add_u32 m0, s69, 16384
    s_add_u32 s93, s54, s55
    buffer_load_dwordx4 v232, s[28:31], s93 offen lds
    s_add_u32 s54, s54, 128
    s_cmp_eq_u32 s54, 896
    s_cselect_b32 s54, 0, s54
    v_min_u32 v9, v9, v8
    v_mul_u32_u24 v8, 1792, v6
    v_lshl_add_u32 v28, v9, 4, v8
    v_add_u32 v8, 2, v7
    v_lshrrev_b32 v8, 3, v8
    v_mul_u32_u24 v8, s78, v8
    v_lshl_add_u32 v28, v8, 30, v28
    v_and_b32 v5, 15, v1
    v_lshrrev_b32 v6, 4, v1
    v_lshrrev_b32 v8, 1, v6
    v_xor_b32 v8, v8, v7
    v_lshlrev_b32 v8, 4, v8
    v_lshl_add_u32 v8, v5, 7, v8
    v_and_b32 v9, 1, v6
    v_lshl_add_u32 v8, v9, 3, v8
    buffer_load_dwordx4 v233, s[28:31], s93 offen offset:1024 lds
    v_add_u32 v26, s60, v8
    v_lshlrev_b32 v18, 7, v5
    v_lshlrev_b32 v7, 12, v7
    v_add_u32 v30, 1776, v7
    v_lshlrev_b32 v7, 9, v6
    v_lshl_add_u32 v20, v5, 4, v7
    v_lshrrev_b32 v7, 1, v6
    v_lshlrev_b32 v7, 4, v7
    v_lshl_add_u32 v7, v9, 2, v7
    v_bfe_u32 v8, v1, 2, 2
    v_add_u32 v7, v7, v8
    v_mul_u32_u24 v7, 224, v7
    v_and_b32 v8, 3, v1
    v_lshl_add_u32 v7, v8, 3, v7
    v_add_u32 v8, 1, v6
    buffer_load_dwordx4 v234, s[28:31], s93 offen offset:2048 lds
    v_lshrrev_b32 v8, 2, v8
    v_mul_u32_u24 v8, 896, v8
    v_sub_u32 v8, v7, v8
    s_mul_i32 s60, s78, 6272
    s_add_u32 s60, s60, 66944
    v_add_u32 v21, s60, v7
    s_add_u32 s60, s60, 1792
    v_add_u32 v22, s60, v8
    s_mul_i32 s13, s78, 4294839040
    s_add_u32 s13, s13, 87808
    v_mul_u32_u24 v7, 0x4925, v1
    v_lshrrev_b32 v7, 18, v7
    v_mul_u32_u24 v8, 14, v7
    v_sub_u32 v8, v1, v8
    v_add_u32 v8, s9, v8
    buffer_load_dwordx4 v235, s[28:31], s93 offen offset:3072 lds
    v_subrev_u32 v9, 14, v8
    v_min_u32 v8, v8, v9
    v_mul_u32_u24 v7, 896, v7
    v_lshl_add_u32 v16, v8, 4, v7
    s_mul_i32 s73, s48, 3584
    s_add_u32 s73, s73, s77
    s_mul_i32 s26, s48, 896
    s_add_u32 s27, s26, 31872
    s_max_u32 s60, s48, 1
    s_sub_u32 s60, s60, s48
    s_mul_i32 s60, s60, 128256
    s_add_u32 s27, s27, s60
    s_cmp_eq_u32 s67, 1
    s_cbranch_scc1 L_yV
    s_waitcnt vmcnt(4)
    ds_read_b128 v[36:39], v239 offset:0
    ds_read_b128 v[40:43], v240 offset:0
    ds_read_b128 v[44:47], v241 offset:0
    ds_read_b128 v[48:51], v242 offset:0
    ds_read_b64_tr_b16 v[180:181], v243 offset:0
    ds_read_b64_tr_b16 v[182:183], v243 offset:512
    ds_read_b64_tr_b16 v[184:185], v244 offset:0
    ds_read_b64_tr_b16 v[186:187], v244 offset:512
    ds_read_b64_tr_b16 v[188:189], v243 offset:2048
    ds_read_b64_tr_b16 v[190:191], v243 offset:2560
    ds_read_b64_tr_b16 v[192:193], v244 offset:2048
    ds_read_b64_tr_b16 v[194:195], v244 offset:2560
    s_waitcnt lgkmcnt(4)
    v_mfma_f32_32x32x16_bf16 v[148:163], v[180:183], v[36:39], 0
    ds_read_b64_tr_b16 v[196:197], v243 offset:4096
    ds_read_b64_tr_b16 v[198:199], v243 offset:4608
    s_add_u32 m0, s7, 0
    s_add_u32 s94, s3, s70
    buffer_load_dwordx4 v238, s[32:35], s94 offen lds
    s_add_u32 s3, s3, 172032
    s_cmp_eq_u32 s3, 1204224
    s_cselect_b32 s3, 0, s3
    v_and_b32 v5, 15, v1
    v_lshlrev_b32 v5, 4, v5
    v_bfe_u32 v6, v1, 4, 1
    v_mfma_f32_32x32x16_bf16 v[164:179], v[184:187], v[36:39], 0
    ds_read_b64_tr_b16 v[200:201], v244 offset:4096
    ds_read_b64_tr_b16 v[202:203], v244 offset:4608
    s_add_u32 m0, s7, 4096
    s_add_u32 s94, s3, s70
    buffer_load_dwordx4 v238, s[32:35], s94 offen lds
    s_add_u32 s3, s3, 172032
    s_cmp_eq_u32 s3, 1204224
    s_cselect_b32 s3, 0, s3
    v_lshrrev_b32 v9, 5, v1
    v_lshl_add_u32 v6, v6, 1, v9
    s_lshl_b32 s60, s66, 4
    s_waitcnt lgkmcnt(4)
    v_mfma_f32_32x32x16_bf16 v[148:163], v[188:191], v[40:43], v[148:163]
    ds_read_b64_tr_b16 v[180:181], v243 offset:6144
    ds_read_b64_tr_b16 v[182:183], v243 offset:6656
    s_add_u32 m0, s7, 8192
    s_add_u32 s94, s3, s70
    buffer_load_dwordx4 v238, s[32:35], s94 offen lds
    s_add_u32 s3, s3, 172032
    s_cmp_eq_u32 s3, 1204224
    s_cselect_b32 s3, 0, s3
    v_add_u32 v6, s60, v6
    v_add_u32 v7, 0, v6
    v_mul_u32_u24 v8, 9363, v7
    v_mfma_f32_32x32x16_bf16 v[164:179], v[192:195], v[40:43], v[164:179]
    ds_read_b64_tr_b16 v[184:185], v244 offset:6144
    ds_read_b64_tr_b16 v[186:187], v244 offset:6656
    s_add_u32 m0, s7, 12288
    s_add_u32 s94, s3, s70
    buffer_load_dwordx4 v238, s[32:35], s94 offen lds
    s_add_u32 s3, s3, 172032
    s_cmp_eq_u32 s3, 1204224
    s_cselect_b32 s3, 0, s3
    v_lshrrev_b32 v8, 16, v8
    v_lshl_add_u32 v246, v8, 18, v5
    v_mul_u32_u24 v8, 7, v8
    s_waitcnt lgkmcnt(4)
    s_waitcnt vmcnt(4)
    v_mfma_f32_32x32x16_bf16 v[148:163], v[196:199], v[44:47], v[148:163]
    ds_read_b128 v[52:55], v239 offset:16384
    ds_read_b128 v[56:59], v240 offset:16384
    ds_read_b128 v[60:63], v241 offset:16384
    ds_read_b128 v[64:67], v242 offset:16384
    s_add_u32 m0, s7, 16384
    s_add_u32 s94, s3, s70
    buffer_load_dwordx4 v238, s[32:35], s94 offen lds
    s_add_u32 s3, s3, 172032
    s_cmp_eq_u32 s3, 1204224
    s_cselect_b32 s3, 0, s3
    v_sub_u32 v7, v7, v8
    v_lshl_add_u32 v246, v7, 8, v246
    v_add_u32 v7, 4, v6
    v_mfma_f32_32x32x16_bf16 v[164:179], v[200:203], v[44:47], v[164:179]
    ds_read_b64_tr_b16 v[188:189], v243 offset:8192
    ds_read_b64_tr_b16 v[190:191], v243 offset:8704
    ds_read_b64_tr_b16 v[192:193], v244 offset:8192
    ds_read_b64_tr_b16 v[194:195], v244 offset:8704
    s_add_u32 m0, s7, 20480
    s_add_u32 s94, s3, s70
    buffer_load_dwordx4 v238, s[32:35], s94 offen lds
    s_add_u32 s3, s3, 172032
    s_cmp_eq_u32 s3, 1204224
    s_cselect_b32 s3, 0, s3
    v_mul_u32_u24 v8, 9363, v7
    v_lshrrev_b32 v8, 16, v8
    v_lshl_add_u32 v247, v8, 18, v5
    s_waitcnt lgkmcnt(8)
    v_mfma_f32_32x32x16_bf16 v[148:163], v[180:183], v[48:51], v[148:163]
    ds_read_b64_tr_b16 v[196:197], v243 offset:10240
    ds_read_b64_tr_b16 v[198:199], v243 offset:10752
    v_mul_u32_u24 v8, 7, v8
    v_sub_u32 v7, v7, v8
    v_lshl_add_u32 v247, v7, 8, v247
    v_mfma_f32_32x32x16_bf16 v[164:179], v[184:187], v[48:51], v[164:179]
    ds_read_b64_tr_b16 v[200:201], v244 offset:10240
    ds_read_b64_tr_b16 v[202:203], v244 offset:10752
    s_add_u32 m0, s7, 24576
    s_add_u32 s94, s3, s70
    buffer_load_dwordx4 v238, s[32:35], s94 offen lds
    s_add_u32 s3, s3, 172032
    s_cmp_eq_u32 s3, 1204224
    s_cselect_b32 s3, 0, s3
    v_add_u32 v7, 8, v6
    v_mul_u32_u24 v8, 9363, v7
    v_lshrrev_b32 v8, 16, v8
    s_waitcnt lgkmcnt(4)
    v_mfma_f32_32x32x16_bf16 v[148:163], v[188:191], v[52:55], v[148:163]
    ds_read_b64_tr_b16 v[180:181], v243 offset:12288
    ds_read_b64_tr_b16 v[182:183], v243 offset:12800
    v_lshl_add_u32 v248, v8, 18, v5
    v_mul_u32_u24 v8, 7, v8
    v_sub_u32 v7, v7, v8
    v_mfma_f32_32x32x16_bf16 v[164:179], v[192:195], v[52:55], v[164:179]
    ds_read_b64_tr_b16 v[184:185], v244 offset:12288
    ds_read_b64_tr_b16 v[186:187], v244 offset:12800
    v_lshl_add_u32 v248, v7, 8, v248
    v_add_u32 v7, 12, v6
    v_mul_u32_u24 v8, 9363, v7
    s_waitcnt lgkmcnt(4)
    v_mfma_f32_32x32x16_bf16 v[148:163], v[196:199], v[56:59], v[148:163]
    ds_read_b64_tr_b16 v[188:189], v243 offset:14336
    ds_read_b64_tr_b16 v[190:191], v243 offset:14848
    v_lshrrev_b32 v8, 16, v8
    v_lshl_add_u32 v249, v8, 18, v5
    v_mul_u32_u24 v8, 7, v8
    v_mfma_f32_32x32x16_bf16 v[164:179], v[200:203], v[56:59], v[164:179]
    ds_read_b64_tr_b16 v[192:193], v244 offset:14336
    ds_read_b64_tr_b16 v[194:195], v244 offset:14848
    v_sub_u32 v7, v7, v8
    v_lshl_add_u32 v249, v7, 8, v249
    s_mul_i32 s62, s66, 149808
    s_waitcnt lgkmcnt(4)
    v_mfma_f32_32x32x16_bf16 v[148:163], v[180:183], v[60:63], v[148:163]
    s_add_u32 s63, s62, 149808
    s_lshr_b32 s62, s62, 16
    s_lshr_b32 s63, s63, 16
    v_mfma_f32_32x32x16_bf16 v[164:179], v[184:187], v[60:63], v[164:179]
    s_sub_u32 s63, s63, s62
    s_lshl_b32 s62, s62, 18
    s_add_u32 s62, s62, 1792
    s_waitcnt lgkmcnt(0)
    v_mfma_f32_32x32x16_bf16 v[148:163], v[188:191], v[64:67], v[148:163]
    v_lshrrev_b32 v6, 4, v1
    v_cmp_gt_u32 vcc, s63, v6
    v_lshl_add_u32 v5, v6, 18, v5
    v_mfma_f32_32x32x16_bf16 v[164:179], v[192:195], v[64:67], v[164:179]
    v_add_u32 v5, s62, v5
    v_mov_b32 v8, 1073741824
    v_cndmask_b32 v250, v8, v5, vcc
    s_add_u32 m0, s69, 0
    s_add_u32 s93, s54, s55
    buffer_load_dwordx4 v232, s[28:31], s93 offen lds
    s_add_u32 s54, s54, 128
    s_cmp_eq_u32 s54, 896
    s_cselect_b32 s54, 0, s54
    buffer_load_dwordx4 v233, s[28:31], s93 offen offset:1024 lds
    buffer_load_dwordx4 v234, s[28:31], s93 offen offset:2048 lds
    buffer_load_dwordx4 v235, s[28:31], s93 offen offset:3072 lds
    s_add_u32 m0, s69, 16384
    s_add_u32 s93, s54, s55
    buffer_load_dwordx4 v232, s[28:31], s93 offen lds
    s_add_u32 s54, s54, 128
    s_cmp_eq_u32 s54, 896
    s_cselect_b32 s54, 0, s54
    buffer_load_dwordx4 v233, s[28:31], s93 offen offset:1024 lds
    buffer_load_dwordx4 v234, s[28:31], s93 offen offset:2048 lds
    buffer_load_dwordx4 v235, s[28:31], s93 offen offset:3072 lds
    s_waitcnt vmcnt(8)
    s_barrier
    ds_read_b64_tr_b16 v[220:221], v245 offset:0
    ds_read_b64_tr_b16 v[222:223], v245 offset:256
    ds_read_b64_tr_b16 v[224:225], v245 offset:1024
    ds_read_b64_tr_b16 v[226:227], v245 offset:1280
    s_waitcnt lgkmcnt(2)
    v_mfma_f32_32x32x16_bf16 v[204:219], v[220:223], v[36:39], 0
    ds_read_b64_tr_b16 v[228:229], v245 offset:2048
    ds_read_b64_tr_b16 v[230:231], v245 offset:2304
    s_waitcnt lgkmcnt(2)
    v_mfma_f32_32x32x16_bf16 v[204:219], v[224:227], v[40:43], v[204:219]
    ds_read_b64_tr_b16 v[220:221], v245 offset:3072
    ds_read_b64_tr_b16 v[222:223], v245 offset:3328
    s_waitcnt lgkmcnt(2)
    s_waitcnt vmcnt(4)
    v_mfma_f32_32x32x16_bf16 v[204:219], v[228:231], v[44:47], v[204:219]
    ds_read_b128 v[68:71], v239 offset:0
    ds_read_b128 v[72:75], v240 offset:0
    ds_read_b128 v[76:79], v241 offset:0
    ds_read_b128 v[80:83], v242 offset:0
    ds_read_b64_tr_b16 v[196:197], v243 offset:16384
    ds_read_b64_tr_b16 v[198:199], v243 offset:16896
    ds_read_b64_tr_b16 v[200:201], v244 offset:16384
    ds_read_b64_tr_b16 v[202:203], v244 offset:16896
    ds_read_b64_tr_b16 v[224:225], v245 offset:4096
    ds_read_b64_tr_b16 v[226:227], v245 offset:4352
    s_waitcnt lgkmcnt(6)
    v_mfma_f32_32x32x16_bf16 v[204:219], v[220:223], v[48:51], v[204:219]
    ds_read_b64_tr_b16 v[180:181], v243 offset:18432
    ds_read_b64_tr_b16 v[182:183], v243 offset:18944
    ds_read_b64_tr_b16 v[184:185], v244 offset:18432
    ds_read_b64_tr_b16 v[186:187], v244 offset:18944
    ds_read_b64_tr_b16 v[228:229], v245 offset:5120
    ds_read_b64_tr_b16 v[230:231], v245 offset:5376
    s_add_u32 m0, s69, 0
    s_add_u32 s93, s54, s55
    buffer_load_dwordx4 v232, s[28:31], s93 offen lds
    s_add_u32 s54, s54, 128
    s_cmp_eq_u32 s54, 896
    s_cselect_b32 s54, 0, s54
    buffer_load_dwordx4 v233, s[28:31], s93 offen offset:1024 lds
    s_waitcnt lgkmcnt(6)
    v_mfma_f32_32x32x16_bf16 v[148:163], v[196:199], v[68:71], v[148:163]
    ds_read_b64_tr_b16 v[188:189], v243 offset:20480
    ds_read_b64_tr_b16 v[190:191], v243 offset:20992
    v_mfma_f32_32x32x16_bf16 v[164:179], v[200:203], v[68:71], v[164:179]
    ds_read_b64_tr_b16 v[192:193], v244 offset:20480
    ds_read_b64_tr_b16 v[194:195], v244 offset:20992
    buffer_load_dwordx4 v234, s[28:31], s93 offen offset:2048 lds
    v_mfma_f32_32x32x16_bf16 v[204:219], v[224:227], v[52:55], v[204:219]
    ds_read_b64_tr_b16 v[220:221], v245 offset:6144
    ds_read_b64_tr_b16 v[222:223], v245 offset:6400
    buffer_load_dwordx4 v235, s[28:31], s93 offen offset:3072 lds
    s_waitcnt lgkmcnt(6)
    v_mfma_f32_32x32x16_bf16 v[148:163], v[180:183], v[72:75], v[148:163]
    ds_read_b64_tr_b16 v[196:197], v243 offset:22528
    ds_read_b64_tr_b16 v[198:199], v243 offset:23040
    v_mfma_f32_32x32x16_bf16 v[164:179], v[184:187], v[72:75], v[164:179]
    ds_read_b64_tr_b16 v[200:201], v244 offset:22528
    ds_read_b64_tr_b16 v[202:203], v244 offset:23040
    v_mfma_f32_32x32x16_bf16 v[204:219], v[228:231], v[56:59], v[204:219]
    ds_read_b64_tr_b16 v[224:225], v245 offset:7168
    ds_read_b64_tr_b16 v[226:227], v245 offset:7424
    s_waitcnt lgkmcnt(6)
    s_waitcnt vmcnt(4)
    v_mfma_f32_32x32x16_bf16 v[148:163], v[188:191], v[76:79], v[148:163]
    ds_read_b128 v[84:87], v239 offset:16384
    ds_read_b128 v[88:91], v240 offset:16384
    ds_read_b128 v[92:95], v241 offset:16384
    v_mfma_f32_32x32x16_bf16 v[164:179], v[192:195], v[76:79], v[164:179]
    ds_read_b128 v[96:99], v242 offset:16384
    ds_read_b64_tr_b16 v[180:181], v243 offset:24576
    ds_read_b64_tr_b16 v[182:183], v243 offset:25088
    v_mfma_f32_32x32x16_bf16 v[204:219], v[220:223], v[60:63], v[204:219]
    ds_read_b64_tr_b16 v[184:185], v244 offset:24576
    ds_read_b64_tr_b16 v[186:187], v244 offset:25088
    ds_read_b64_tr_b16 v[228:229], v245 offset:8192
    s_waitcnt lgkmcnt(11)
    ds_read_b64_tr_b16 v[230:231], v245 offset:8448
    s_waitcnt lgkmcnt(6)
    v_mfma_f32_32x32x16_bf16 v[148:163], v[196:199], v[80:83], v[148:163]
    ds_read_b64_tr_b16 v[188:189], v243 offset:26624
    ds_read_b64_tr_b16 v[190:191], v243 offset:27136
    v_mfma_f32_32x32x16_bf16 v[164:179], v[200:203], v[80:83], v[164:179]
    ds_read_b64_tr_b16 v[192:193], v244 offset:26624
    ds_read_b64_tr_b16 v[194:195], v244 offset:27136
    s_add_u32 m0, s69, 16384
    s_add_u32 s93, s54, s55
    buffer_load_dwordx4 v232, s[28:31], s93 offen lds
    s_add_u32 s54, s54, 128
    s_cmp_eq_u32 s54, 896
    s_cselect_b32 s54, 0, s54
    v_mfma_f32_32x32x16_bf16 v[204:219], v[224:227], v[64:67], v[204:219]
    ds_read_b64_tr_b16 v[220:221], v245 offset:9216
    ds_read_b64_tr_b16 v[222:223], v245 offset:9472
    buffer_load_dwordx4 v233, s[28:31], s93 offen offset:1024 lds
    s_waitcnt lgkmcnt(6)
    v_mfma_f32_32x32x16_bf16 v[148:163], v[180:183], v[84:87], v[148:163]
    ds_read_b64_tr_b16 v[196:197], v243 offset:28672
    ds_read_b64_tr_b16 v[198:199], v243 offset:29184
    v_mfma_f32_32x32x16_bf16 v[164:179], v[184:187], v[84:87], v[164:179]
    ds_read_b64_tr_b16 v[200:201], v244 offset:28672
    ds_read_b64_tr_b16 v[202:203], v244 offset:29184
    buffer_load_dwordx4 v234, s[28:31], s93 offen offset:2048 lds
    v_mfma_f32_32x32x16_bf16 v[204:219], v[228:231], v[68:71], v[204:219]
    ds_read_b64_tr_b16 v[224:225], v245 offset:10240
    ds_read_b64_tr_b16 v[226:227], v245 offset:10496
    buffer_load_dwordx4 v235, s[28:31], s93 offen offset:3072 lds
    s_waitcnt lgkmcnt(6)
    v_mfma_f32_32x32x16_bf16 v[148:163], v[188:191], v[88:91], v[148:163]
    ds_read_b64_tr_b16 v[180:181], v243 offset:30720
    ds_read_b64_tr_b16 v[182:183], v243 offset:31232
    v_mfma_f32_32x32x16_bf16 v[164:179], v[192:195], v[88:91], v[164:179]
    ds_read_b64_tr_b16 v[184:185], v244 offset:30720
    ds_read_b64_tr_b16 v[186:187], v244 offset:31232
    v_mfma_f32_32x32x16_bf16 v[204:219], v[220:223], v[72:75], v[204:219]
    ds_read_b64_tr_b16 v[228:229], v245 offset:11264
    ds_read_b64_tr_b16 v[230:231], v245 offset:11520
    s_waitcnt lgkmcnt(6)
    s_waitcnt vmcnt(4)
    v_mfma_f32_32x32x16_bf16 v[148:163], v[196:199], v[92:95], v[148:163]
    ds_read_b128 v[100:103], v239 offset:0
    ds_read_b128 v[104:107], v240 offset:0
    ds_read_b128 v[108:111], v241 offset:0
    v_mfma_f32_32x32x16_bf16 v[164:179], v[200:203], v[92:95], v[164:179]
    ds_read_b128 v[112:115], v242 offset:0
    ds_read_b64_tr_b16 v[188:189], v243 offset:32768
    ds_read_b64_tr_b16 v[190:191], v243 offset:33280
    v_mfma_f32_32x32x16_bf16 v[204:219], v[224:227], v[76:79], v[204:219]
    ds_read_b64_tr_b16 v[192:193], v244 offset:32768
    ds_read_b64_tr_b16 v[194:195], v244 offset:33280
    ds_read_b64_tr_b16 v[220:221], v245 offset:12288
    s_waitcnt lgkmcnt(11)
    ds_read_b64_tr_b16 v[222:223], v245 offset:12544
    s_waitcnt lgkmcnt(6)
    v_mfma_f32_32x32x16_bf16 v[148:163], v[180:183], v[96:99], v[148:163]
    ds_read_b64_tr_b16 v[196:197], v243 offset:34816
    ds_read_b64_tr_b16 v[198:199], v243 offset:35328
    v_mfma_f32_32x32x16_bf16 v[164:179], v[184:187], v[96:99], v[164:179]
    ds_read_b64_tr_b16 v[200:201], v244 offset:34816
    ds_read_b64_tr_b16 v[202:203], v244 offset:35328
    s_add_u32 m0, s69, 0
    s_add_u32 s93, s54, s55
    buffer_load_dwordx4 v232, s[28:31], s93 offen lds
    s_add_u32 s54, s54, 128
    s_cmp_eq_u32 s54, 896
    s_cselect_b32 s54, 0, s54
    v_mfma_f32_32x32x16_bf16 v[204:219], v[228:231], v[80:83], v[204:219]
    ds_read_b64_tr_b16 v[224:225], v245 offset:13312
    ds_read_b64_tr_b16 v[226:227], v245 offset:13568
    buffer_load_dwordx4 v233, s[28:31], s93 offen offset:1024 lds
    s_waitcnt lgkmcnt(6)
    v_mfma_f32_32x32x16_bf16 v[148:163], v[188:191], v[100:103], v[148:163]
    ds_read_b64_tr_b16 v[180:181], v243 offset:36864
    ds_read_b64_tr_b16 v[182:183], v243 offset:37376
    v_mfma_f32_32x32x16_bf16 v[164:179], v[192:195], v[100:103], v[164:179]
    ds_read_b64_tr_b16 v[184:185], v244 offset:36864
    ds_read_b64_tr_b16 v[186:187], v244 offset:37376
    buffer_load_dwordx4 v234, s[28:31], s93 offen offset:2048 lds
    v_mfma_f32_32x32x16_bf16 v[204:219], v[220:223], v[84:87], v[204:219]
    ds_read_b64_tr_b16 v[228:229], v245 offset:14336
    ds_read_b64_tr_b16 v[230:231], v245 offset:14592
    buffer_load_dwordx4 v235, s[28:31], s93 offen offset:3072 lds
    s_waitcnt lgkmcnt(6)
    v_mfma_f32_32x32x16_bf16 v[148:163], v[196:199], v[104:107], v[148:163]
    ds_read_b64_tr_b16 v[188:189], v243 offset:38912
    ds_read_b64_tr_b16 v[190:191], v243 offset:39424
    v_mfma_f32_32x32x16_bf16 v[164:179], v[200:203], v[104:107], v[164:179]
    ds_read_b64_tr_b16 v[192:193], v244 offset:38912
    ds_read_b64_tr_b16 v[194:195], v244 offset:39424
    v_mfma_f32_32x32x16_bf16 v[204:219], v[224:227], v[88:91], v[204:219]
    ds_read_b64_tr_b16 v[220:221], v245 offset:15360
    ds_read_b64_tr_b16 v[222:223], v245 offset:15616
    s_waitcnt lgkmcnt(6)
    s_waitcnt vmcnt(4)
    v_mfma_f32_32x32x16_bf16 v[148:163], v[180:183], v[108:111], v[148:163]
    ds_read_b128 v[116:119], v239 offset:16384
    ds_read_b128 v[120:123], v240 offset:16384
    ds_read_b128 v[124:127], v241 offset:16384
    v_mfma_f32_32x32x16_bf16 v[164:179], v[184:187], v[108:111], v[164:179]
    ds_read_b128 v[128:131], v242 offset:16384
    ds_read_b64_tr_b16 v[196:197], v243 offset:40960
    ds_read_b64_tr_b16 v[198:199], v243 offset:41472
    v_mfma_f32_32x32x16_bf16 v[204:219], v[228:231], v[92:95], v[204:219]
    ds_read_b64_tr_b16 v[200:201], v244 offset:40960
    ds_read_b64_tr_b16 v[202:203], v244 offset:41472
    ds_read_b64_tr_b16 v[224:225], v245 offset:16384
    s_waitcnt lgkmcnt(11)
    ds_read_b64_tr_b16 v[226:227], v245 offset:16640
    s_waitcnt lgkmcnt(10)
    v_mfma_f32_32x32x16_bf16 v[148:163], v[188:191], v[112:115], v[148:163]
    ds_read_b64_tr_b16 v[180:181], v243 offset:43008
    ds_read_b64_tr_b16 v[182:183], v243 offset:43520
    v_mfma_f32_32x32x16_bf16 v[164:179], v[192:195], v[112:115], v[164:179]
    ds_read_b64_tr_b16 v[184:185], v244 offset:43008
    ds_read_b64_tr_b16 v[186:187], v244 offset:43520
    v_mfma_f32_32x32x16_bf16 v[204:219], v[220:223], v[96:99], v[204:219]
    ds_read_b64_tr_b16 v[228:229], v245 offset:17408
    s_waitcnt lgkmcnt(11)
    ds_read_b64_tr_b16 v[230:231], v245 offset:17664
    s_waitcnt lgkmcnt(6)
    v_mfma_f32_32x32x16_bf16 v[148:163], v[196:199], v[116:119], v[148:163]
    ds_read_b64_tr_b16 v[188:189], v243 offset:45056
    ds_read_b64_tr_b16 v[190:191], v243 offset:45568
    v_mfma_f32_32x32x16_bf16 v[164:179], v[200:203], v[116:119], v[164:179]
    ds_read_b64_tr_b16 v[192:193], v244 offset:45056
    ds_read_b64_tr_b16 v[194:195], v244 offset:45568
    v_mfma_f32_32x32x16_bf16 v[204:219], v[224:227], v[100:103], v[204:219]
    ds_read_b64_tr_b16 v[220:221], v245 offset:18432
    ds_read_b64_tr_b16 v[222:223], v245 offset:18688
    s_waitcnt lgkmcnt(6)
    v_mfma_f32_32x32x16_bf16 v[148:163], v[180:183], v[120:123], v[148:163]
    ds_read_b64_tr_b16 v[196:197], v243 offset:47104
    ds_read_b64_tr_b16 v[198:199], v243 offset:47616
    v_mfma_f32_32x32x16_bf16 v[164:179], v[184:187], v[120:123], v[164:179]
    ds_read_b64_tr_b16 v[200:201], v244 offset:47104
    ds_read_b64_tr_b16 v[202:203], v244 offset:47616
    v_mfma_f32_32x32x16_bf16 v[204:219], v[228:231], v[104:107], v[204:219]
    ds_read_b64_tr_b16 v[224:225], v245 offset:19456
    ds_read_b64_tr_b16 v[226:227], v245 offset:19712
    s_waitcnt lgkmcnt(6)
    s_waitcnt vmcnt(0)
    v_mfma_f32_32x32x16_bf16 v[148:163], v[188:191], v[124:127], v[148:163]
    ds_read_b128 v[132:135], v239 offset:0
    ds_read_b128 v[136:139], v240 offset:0
    ds_read_b128 v[140:143], v241 offset:0
    v_mfma_f32_32x32x16_bf16 v[164:179], v[192:195], v[124:127], v[164:179]
    ds_read_b128 v[144:147], v242 offset:0
    ds_read_b64_tr_b16 v[180:181], v243 offset:49152
    ds_read_b64_tr_b16 v[182:183], v243 offset:49664
    v_mfma_f32_32x32x16_bf16 v[204:219], v[220:223], v[108:111], v[204:219]
    ds_read_b64_tr_b16 v[184:185], v244 offset:49152
    ds_read_b64_tr_b16 v[186:187], v244 offset:49664
    ds_read_b64_tr_b16 v[228:229], v245 offset:20480
    s_waitcnt lgkmcnt(11)
    ds_read_b64_tr_b16 v[230:231], v245 offset:20736
    s_waitcnt lgkmcnt(10)
    v_mfma_f32_32x32x16_bf16 v[148:163], v[196:199], v[128:131], v[148:163]
    ds_read_b64_tr_b16 v[188:189], v243 offset:51200
    ds_read_b64_tr_b16 v[190:191], v243 offset:51712
    v_mfma_f32_32x32x16_bf16 v[164:179], v[200:203], v[128:131], v[164:179]
    ds_read_b64_tr_b16 v[192:193], v244 offset:51200
    ds_read_b64_tr_b16 v[194:195], v244 offset:51712
    v_mfma_f32_32x32x16_bf16 v[204:219], v[224:227], v[112:115], v[204:219]
    ds_read_b64_tr_b16 v[220:221], v245 offset:21504
    s_waitcnt lgkmcnt(11)
    ds_read_b64_tr_b16 v[222:223], v245 offset:21760
    s_waitcnt lgkmcnt(6)
    v_mfma_f32_32x32x16_bf16 v[148:163], v[180:183], v[132:135], v[148:163]
    ds_read_b64_tr_b16 v[196:197], v243 offset:53248
    ds_read_b64_tr_b16 v[198:199], v243 offset:53760
    v_mfma_f32_32x32x16_bf16 v[164:179], v[184:187], v[132:135], v[164:179]
    ds_read_b64_tr_b16 v[200:201], v244 offset:53248
    ds_read_b64_tr_b16 v[202:203], v244 offset:53760
    v_mfma_f32_32x32x16_bf16 v[204:219], v[228:231], v[116:119], v[204:219]
    ds_read_b64_tr_b16 v[224:225], v245 offset:22528
    ds_read_b64_tr_b16 v[226:227], v245 offset:22784
    buffer_store_dwordx4 v[252:255], v250, s[36:39], s92 offen offset:0 sc1
    s_waitcnt lgkmcnt(6)
    v_mfma_f32_32x32x16_bf16 v[148:163], v[188:191], v[136:139], v[148:163]
    ds_read_b64_tr_b16 v[180:181], v243 offset:55296
    ds_read_b64_tr_b16 v[182:183], v243 offset:55808
    v_mfma_f32_32x32x16_bf16 v[164:179], v[192:195], v[136:139], v[164:179]
    ds_read_b64_tr_b16 v[184:185], v244 offset:55296
    ds_read_b64_tr_b16 v[186:187], v244 offset:55808
    v_mfma_f32_32x32x16_bf16 v[204:219], v[220:223], v[120:123], v[204:219]
    ds_read_b64_tr_b16 v[228:229], v245 offset:23552
    ds_read_b64_tr_b16 v[230:231], v245 offset:23808
    s_waitcnt lgkmcnt(6)
    v_mfma_f32_32x32x16_bf16 v[148:163], v[196:199], v[140:143], v[148:163]
    v_mfma_f32_32x32x16_bf16 v[164:179], v[200:203], v[140:143], v[164:179]
    ds_read_b64_tr_b16 v[220:221], v245 offset:24576
    v_mfma_f32_32x32x16_bf16 v[204:219], v[224:227], v[124:127], v[204:219]
    ds_read_b64_tr_b16 v[222:223], v245 offset:24832
    s_waitcnt lgkmcnt(2)
    v_mfma_f32_32x32x16_bf16 v[148:163], v[180:183], v[144:147], v[148:163]
    v_mfma_f32_32x32x16_bf16 v[164:179], v[184:187], v[144:147], v[164:179]
    ds_read_b64_tr_b16 v[224:225], v245 offset:25600
    v_mfma_f32_32x32x16_bf16 v[204:219], v[228:231], v[128:131], v[204:219]
    ds_read_b64_tr_b16 v[226:227], v245 offset:25856
    s_waitcnt lgkmcnt(2)
    v_mfma_f32_32x32x16_bf16 v[204:219], v[220:223], v[132:135], v[204:219]
    ds_read_b64_tr_b16 v[228:229], v245 offset:26624
    ds_read_b64_tr_b16 v[230:231], v245 offset:26880
    s_waitcnt lgkmcnt(2)
    v_mfma_f32_32x32x16_bf16 v[204:219], v[224:227], v[136:139], v[204:219]
    ds_read_b64_tr_b16 v[220:221], v245 offset:27648
    ds_read_b64_tr_b16 v[222:223], v245 offset:27904
    v_cvt_pk_bf16_f32 v180, v148, v149
    v_cvt_pk_bf16_f32 v181, v150, v151
    v_cvt_pk_bf16_f32 v182, v152, v153
    v_cvt_pk_bf16_f32 v183, v154, v155
    v_cvt_pk_bf16_f32 v184, v156, v157
    v_cvt_pk_bf16_f32 v185, v158, v159
    v_cvt_pk_bf16_f32 v186, v160, v161
    v_cvt_pk_bf16_f32 v187, v162, v163
    s_mov_b64 exec, 0xffff
    buffer_load_dword v34, v17, s[36:39], s5 offen sc1
    s_mov_b64 exec, -1
    s_waitcnt lgkmcnt(2)
    v_mfma_f32_32x32x16_bf16 v[204:219], v[228:231], v[140:143], v[204:219]
    v_permlane16_swap_b32 v180, v182
    v_permlane16_swap_b32 v181, v183
    v_permlane16_swap_b32 v184, v186
    v_permlane16_swap_b32 v185, v187
    v_cvt_pk_bf16_f32 v188, v164, v165
    v_cvt_pk_bf16_f32 v189, v166, v167
    v_cvt_pk_bf16_f32 v190, v168, v169
    v_cvt_pk_bf16_f32 v191, v170, v171
    s_waitcnt lgkmcnt(0)
    v_mfma_f32_32x32x16_bf16 v[204:219], v[220:223], v[144:147], v[204:219]
    v_cvt_pk_bf16_f32 v192, v172, v173
    v_cvt_pk_bf16_f32 v193, v174, v175
    v_cvt_pk_bf16_f32 v194, v176, v177
    v_cvt_pk_bf16_f32 v195, v178, v179
    v_permlane16_swap_b32 v188, v190
    v_permlane16_swap_b32 v189, v191
    v_permlane16_swap_b32 v192, v194
    v_permlane16_swap_b32 v193, v195
    s_nop 3
    v_pk_mul_f32 v[204:205], v[204:205], s[90:91]
    v_pk_mul_f32 v[206:207], v[206:207], s[90:91]
    v_pk_mul_f32 v[208:209], v[208:209], s[90:91]
    v_pk_mul_f32 v[210:211], v[210:211], s[90:91]
    v_pk_mul_f32 v[212:213], v[212:213], s[90:91]
    v_pk_mul_f32 v[214:215], v[214:215], s[90:91]
    v_pk_mul_f32 v[216:217], v[216:217], s[90:91]
    v_pk_mul_f32 v[218:219], v[218:219], s[90:91]
    v_cvt_pk_bf16_f32 v196, v204, v205
    v_cvt_pk_bf16_f32 v197, v206, v207
    v_cvt_pk_bf16_f32 v198, v208, v209
    v_cvt_pk_bf16_f32 v199, v210, v211
    v_cvt_pk_bf16_f32 v200, v212, v213
    v_cvt_pk_bf16_f32 v201, v214, v215
    v_cvt_pk_bf16_f32 v202, v216, v217
    v_cvt_pk_bf16_f32 v203, v218, v219
    v_mov_b32 v10, 16640
    v_cndmask_b32 v203, 0, v203, s[64:65]
    v_cndmask_b32 v202, v10, v202, s[64:65]
    ds_write_b128 v12, v[196:199]
    ds_write_b128 v12, v[200:203] offset:1024
    s_waitcnt lgkmcnt(0)
    s_branch L_b0
L_yV:
    s_waitcnt vmcnt(4)
    ds_read_b128 v[36:39], v239 offset:0
    ds_read_b128 v[40:43], v240 offset:0
    ds_read_b128 v[44:47], v241 offset:0
    ds_read_b128 v[48:51], v242 offset:0
    ds_read_b64_tr_b16 v[180:181], v243 offset:0
    ds_read_b64_tr_b16 v[182:183], v243 offset:512
    ds_read_b64_tr_b16 v[184:185], v244 offset:0
    ds_read_b64_tr_b16 v[186:187], v244 offset:512
    ds_read_b64_tr_b16 v[188:189], v243 offset:2048
    ds_read_b64_tr_b16 v[190:191], v243 offset:2560
    ds_read_b64_tr_b16 v[192:193], v244 offset:2048
    ds_read_b64_tr_b16 v[194:195], v244 offset:2560
    s_waitcnt lgkmcnt(4)
    v_mfma_f32_32x32x16_bf16 v[148:163], v[36:39], v[180:183], 0
    ds_read_b64_tr_b16 v[196:197], v243 offset:4096
    ds_read_b64_tr_b16 v[198:199], v243 offset:4608
    s_add_u32 m0, s7, 0
    s_add_u32 s94, s3, s70
    buffer_load_dwordx4 v238, s[32:35], s94 offen lds
    s_add_u32 s3, s3, 172032
    s_cmp_eq_u32 s3, 1204224
    s_cselect_b32 s3, 0, s3
    v_and_b32 v5, 31, v1
    s_lshl_b32 s60, s66, 6
    v_add_u32 v5, s60, v5
    v_mfma_f32_32x32x16_bf16 v[164:179], v[36:39], v[184:187], 0
    ds_read_b64_tr_b16 v[200:201], v244 offset:4096
    ds_read_b64_tr_b16 v[202:203], v244 offset:4608
    s_add_u32 m0, s7, 4096
    s_add_u32 s94, s3, s70
    buffer_load_dwordx4 v238, s[32:35], s94 offen lds
    s_add_u32 s3, s3, 172032
    s_cmp_eq_u32 s3, 1204224
    s_cselect_b32 s3, 0, s3
    v_and_b32 v9, 32, v1
    v_add_u32 v7, 0, v5
    v_mul_u32_u24 v8, 2341, v7
    s_waitcnt lgkmcnt(4)
    v_mfma_f32_32x32x16_bf16 v[148:163], v[40:43], v[188:191], v[148:163]
    ds_read_b64_tr_b16 v[180:181], v243 offset:6144
    ds_read_b64_tr_b16 v[182:183], v243 offset:6656
    s_add_u32 m0, s7, 8192
    s_add_u32 s94, s3, s70
    buffer_load_dwordx4 v238, s[32:35], s94 offen lds
    s_add_u32 s3, s3, 172032
    s_cmp_eq_u32 s3, 1204224
    s_cselect_b32 s3, 0, s3
    v_lshrrev_b32 v8, 16, v8
    v_mul_u32_u24 v6, 28, v8
    v_sub_u32 v7, v7, v6
    v_mfma_f32_32x32x16_bf16 v[164:179], v[40:43], v[192:195], v[164:179]
    ds_read_b64_tr_b16 v[184:185], v244 offset:6144
    ds_read_b64_tr_b16 v[186:187], v244 offset:6656
    s_add_u32 m0, s7, 12288
    s_add_u32 s94, s3, s70
    buffer_load_dwordx4 v238, s[32:35], s94 offen lds
    s_add_u32 s3, s3, 172032
    s_cmp_eq_u32 s3, 1204224
    s_cselect_b32 s3, 0, s3
    v_add_u32 v7, v7, v9
    v_lshlrev_b32 v7, 4, v7
    v_lshl_add_u32 v7, v8, 18, v7
    s_waitcnt lgkmcnt(4)
    s_waitcnt vmcnt(4)
    v_mfma_f32_32x32x16_bf16 v[148:163], v[44:47], v[196:199], v[148:163]
    ds_read_b128 v[52:55], v239 offset:16384
    ds_read_b128 v[56:59], v240 offset:16384
    ds_read_b128 v[60:63], v241 offset:16384
    ds_read_b128 v[64:67], v242 offset:16384
    s_add_u32 m0, s7, 16384
    s_add_u32 s94, s3, s70
    buffer_load_dwordx4 v238, s[32:35], s94 offen lds
    s_add_u32 s3, s3, 172032
    s_cmp_eq_u32 s3, 1204224
    s_cselect_b32 s3, 0, s3
    v_add_u32 v246, 2048, v7
    v_add_u32 v247, 3072, v7
    v_add_u32 v7, 32, v5
    v_mfma_f32_32x32x16_bf16 v[164:179], v[44:47], v[200:203], v[164:179]
    ds_read_b64_tr_b16 v[188:189], v243 offset:8192
    ds_read_b64_tr_b16 v[190:191], v243 offset:8704
    ds_read_b64_tr_b16 v[192:193], v244 offset:8192
    ds_read_b64_tr_b16 v[194:195], v244 offset:8704
    s_add_u32 m0, s7, 20480
    s_add_u32 s94, s3, s70
    buffer_load_dwordx4 v238, s[32:35], s94 offen lds
    s_add_u32 s3, s3, 172032
    s_cmp_eq_u32 s3, 1204224
    s_cselect_b32 s3, 0, s3
    v_mul_u32_u24 v8, 2341, v7
    v_lshrrev_b32 v8, 16, v8
    v_mul_u32_u24 v6, 28, v8
    s_waitcnt lgkmcnt(8)
    v_mfma_f32_32x32x16_bf16 v[148:163], v[48:51], v[180:183], v[148:163]
    ds_read_b64_tr_b16 v[196:197], v243 offset:10240
    ds_read_b64_tr_b16 v[198:199], v243 offset:10752
    v_sub_u32 v7, v7, v6
    v_add_u32 v7, v7, v9
    v_lshlrev_b32 v7, 4, v7
    v_mfma_f32_32x32x16_bf16 v[164:179], v[48:51], v[184:187], v[164:179]
    ds_read_b64_tr_b16 v[200:201], v244 offset:10240
    ds_read_b64_tr_b16 v[202:203], v244 offset:10752
    s_add_u32 m0, s7, 24576
    s_add_u32 s94, s3, s70
    buffer_load_dwordx4 v238, s[32:35], s94 offen lds
    s_add_u32 s3, s3, 172032
    s_cmp_eq_u32 s3, 1204224
    s_cselect_b32 s3, 0, s3
    v_lshl_add_u32 v7, v8, 18, v7
    v_add_u32 v248, 2048, v7
    v_add_u32 v249, 3072, v7
    s_waitcnt lgkmcnt(4)
    v_mfma_f32_32x32x16_bf16 v[148:163], v[52:55], v[188:191], v[148:163]
    ds_read_b64_tr_b16 v[180:181], v243 offset:12288
    ds_read_b64_tr_b16 v[182:183], v243 offset:12800
    s_mul_i32 s62, s66, 149808
    s_add_u32 s63, s62, 149808
    s_lshr_b32 s62, s62, 16
    v_mfma_f32_32x32x16_bf16 v[164:179], v[52:55], v[192:195], v[164:179]
    ds_read_b64_tr_b16 v[184:185], v244 offset:12288
    ds_read_b64_tr_b16 v[186:187], v244 offset:12800
    s_lshr_b32 s63, s63, 16
    s_sub_u32 s63, s63, s62
    s_lshl_b32 s62, s62, 18
    s_waitcnt lgkmcnt(4)
    v_mfma_f32_32x32x16_bf16 v[148:163], v[56:59], v[196:199], v[148:163]
    ds_read_b64_tr_b16 v[188:189], v243 offset:14336
    ds_read_b64_tr_b16 v[190:191], v243 offset:14848
    s_add_u32 s62, s62, 2496
    v_lshrrev_b32 v5, 4, v1
    v_cmp_gt_u32 vcc, s63, v5
    v_mfma_f32_32x32x16_bf16 v[164:179], v[56:59], v[200:203], v[164:179]
    ds_read_b64_tr_b16 v[192:193], v244 offset:14336
    ds_read_b64_tr_b16 v[194:195], v244 offset:14848
    v_bfe_u32 v6, v1, 2, 2
    v_lshlrev_b32 v6, 9, v6
    v_lshl_add_u32 v6, v5, 18, v6
    s_waitcnt lgkmcnt(4)
    v_mfma_f32_32x32x16_bf16 v[148:163], v[60:63], v[180:183], v[148:163]
    v_and_b32 v7, 3, v1
    v_lshl_add_u32 v6, v7, 4, v6
    v_add_u32 v6, s62, v6
    v_mfma_f32_32x32x16_bf16 v[164:179], v[60:63], v[184:187], v[164:179]
    v_mov_b32 v8, 1073741824
    v_cndmask_b32 v250, v8, v6, vcc
    v_cmp_eq_u32 vcc, 0, v7
    s_waitcnt lgkmcnt(0)
    v_mfma_f32_32x32x16_bf16 v[148:163], v[64:67], v[188:191], v[148:163]
    v_mov_b32 v8, 0x3f803f80
    s_nop 0
    v_cndmask_b32 v252, 0, v8, vcc
    v_mfma_f32_32x32x16_bf16 v[164:179], v[64:67], v[192:195], v[164:179]
    v_mov_b32 v253, v252
    v_mov_b32 v254, v252
    v_mov_b32 v255, v252
    s_add_u32 m0, s69, 0
    s_add_u32 s93, s54, s55
    buffer_load_dwordx4 v232, s[28:31], s93 offen lds
    s_add_u32 s54, s54, 128
    s_cmp_eq_u32 s54, 896
    s_cselect_b32 s54, 0, s54
    buffer_load_dwordx4 v233, s[28:31], s93 offen offset:1024 lds
    buffer_load_dwordx4 v234, s[28:31], s93 offen offset:2048 lds
    buffer_load_dwordx4 v235, s[28:31], s93 offen offset:3072 lds
    s_add_u32 m0, s69, 16384
    s_add_u32 s93, s54, s55
    buffer_load_dwordx4 v232, s[28:31], s93 offen lds
    s_add_u32 s54, s54, 128
    s_cmp_eq_u32 s54, 896
    s_cselect_b32 s54, 0, s54
    buffer_load_dwordx4 v233, s[28:31], s93 offen offset:1024 lds
    buffer_load_dwordx4 v234, s[28:31], s93 offen offset:2048 lds
    buffer_load_dwordx4 v235, s[28:31], s93 offen offset:3072 lds
    s_waitcnt vmcnt(8)
    s_barrier
    ds_read_b64_tr_b16 v[220:221], v245 offset:0
    ds_read_b64_tr_b16 v[222:223], v245 offset:256
    ds_read_b64_tr_b16 v[224:225], v245 offset:1024
    ds_read_b64_tr_b16 v[226:227], v245 offset:1280
    s_waitcnt lgkmcnt(2)
    v_mfma_f32_32x32x16_bf16 v[204:219], v[220:223], v[36:39], 0
    ds_read_b64_tr_b16 v[228:229], v245 offset:2048
    ds_read_b64_tr_b16 v[230:231], v245 offset:2304
    s_waitcnt lgkmcnt(2)
    v_mfma_f32_32x32x16_bf16 v[204:219], v[224:227], v[40:43], v[204:219]
    ds_read_b64_tr_b16 v[220:221], v245 offset:3072
    ds_read_b64_tr_b16 v[222:223], v245 offset:3328
    s_waitcnt lgkmcnt(2)
    s_waitcnt vmcnt(4)
    v_mfma_f32_32x32x16_bf16 v[204:219], v[228:231], v[44:47], v[204:219]
    ds_read_b128 v[68:71], v239 offset:0
    ds_read_b128 v[72:75], v240 offset:0
    ds_read_b128 v[76:79], v241 offset:0
    ds_read_b128 v[80:83], v242 offset:0
    ds_read_b64_tr_b16 v[196:197], v243 offset:16384
    ds_read_b64_tr_b16 v[198:199], v243 offset:16896
    ds_read_b64_tr_b16 v[200:201], v244 offset:16384
    ds_read_b64_tr_b16 v[202:203], v244 offset:16896
    ds_read_b64_tr_b16 v[224:225], v245 offset:4096
    ds_read_b64_tr_b16 v[226:227], v245 offset:4352
    s_waitcnt lgkmcnt(6)
    v_mfma_f32_32x32x16_bf16 v[204:219], v[220:223], v[48:51], v[204:219]
    ds_read_b64_tr_b16 v[180:181], v243 offset:18432
    ds_read_b64_tr_b16 v[182:183], v243 offset:18944
    ds_read_b64_tr_b16 v[184:185], v244 offset:18432
    ds_read_b64_tr_b16 v[186:187], v244 offset:18944
    ds_read_b64_tr_b16 v[228:229], v245 offset:5120
    ds_read_b64_tr_b16 v[230:231], v245 offset:5376
    s_add_u32 m0, s69, 0
    s_add_u32 s93, s54, s55
    buffer_load_dwordx4 v232, s[28:31], s93 offen lds
    s_add_u32 s54, s54, 128
    s_cmp_eq_u32 s54, 896
    s_cselect_b32 s54, 0, s54
    buffer_load_dwordx4 v233, s[28:31], s93 offen offset:1024 lds
    s_waitcnt lgkmcnt(6)
    v_mfma_f32_32x32x16_bf16 v[148:163], v[68:71], v[196:199], v[148:163]
    ds_read_b64_tr_b16 v[188:189], v243 offset:20480
    ds_read_b64_tr_b16 v[190:191], v243 offset:20992
    v_mfma_f32_32x32x16_bf16 v[164:179], v[68:71], v[200:203], v[164:179]
    ds_read_b64_tr_b16 v[192:193], v244 offset:20480
    ds_read_b64_tr_b16 v[194:195], v244 offset:20992
    buffer_load_dwordx4 v234, s[28:31], s93 offen offset:2048 lds
    v_mfma_f32_32x32x16_bf16 v[204:219], v[224:227], v[52:55], v[204:219]
    ds_read_b64_tr_b16 v[220:221], v245 offset:6144
    ds_read_b64_tr_b16 v[222:223], v245 offset:6400
    buffer_load_dwordx4 v235, s[28:31], s93 offen offset:3072 lds
    s_waitcnt lgkmcnt(6)
    v_mfma_f32_32x32x16_bf16 v[148:163], v[72:75], v[180:183], v[148:163]
    ds_read_b64_tr_b16 v[196:197], v243 offset:22528
    ds_read_b64_tr_b16 v[198:199], v243 offset:23040
    v_mfma_f32_32x32x16_bf16 v[164:179], v[72:75], v[184:187], v[164:179]
    ds_read_b64_tr_b16 v[200:201], v244 offset:22528
    ds_read_b64_tr_b16 v[202:203], v244 offset:23040
    v_mfma_f32_32x32x16_bf16 v[204:219], v[228:231], v[56:59], v[204:219]
    ds_read_b64_tr_b16 v[224:225], v245 offset:7168
    ds_read_b64_tr_b16 v[226:227], v245 offset:7424
    s_waitcnt lgkmcnt(6)
    s_waitcnt vmcnt(4)
    v_mfma_f32_32x32x16_bf16 v[148:163], v[76:79], v[188:191], v[148:163]
    ds_read_b128 v[84:87], v239 offset:16384
    ds_read_b128 v[88:91], v240 offset:16384
    ds_read_b128 v[92:95], v241 offset:16384
    v_mfma_f32_32x32x16_bf16 v[164:179], v[76:79], v[192:195], v[164:179]
    ds_read_b128 v[96:99], v242 offset:16384
    ds_read_b64_tr_b16 v[180:181], v243 offset:24576
    ds_read_b64_tr_b16 v[182:183], v243 offset:25088
    v_mfma_f32_32x32x16_bf16 v[204:219], v[220:223], v[60:63], v[204:219]
    ds_read_b64_tr_b16 v[184:185], v244 offset:24576
    ds_read_b64_tr_b16 v[186:187], v244 offset:25088
    ds_read_b64_tr_b16 v[228:229], v245 offset:8192
    s_waitcnt lgkmcnt(11)
    ds_read_b64_tr_b16 v[230:231], v245 offset:8448
    s_waitcnt lgkmcnt(6)
    v_mfma_f32_32x32x16_bf16 v[148:163], v[80:83], v[196:199], v[148:163]
    ds_read_b64_tr_b16 v[188:189], v243 offset:26624
    ds_read_b64_tr_b16 v[190:191], v243 offset:27136
    v_mfma_f32_32x32x16_bf16 v[164:179], v[80:83], v[200:203], v[164:179]
    ds_read_b64_tr_b16 v[192:193], v244 offset:26624
    ds_read_b64_tr_b16 v[194:195], v244 offset:27136
    s_add_u32 m0, s69, 16384
    s_add_u32 s93, s54, s55
    buffer_load_dwordx4 v232, s[28:31], s93 offen lds
    s_add_u32 s54, s54, 128
    s_cmp_eq_u32 s54, 896
    s_cselect_b32 s54, 0, s54
    v_mfma_f32_32x32x16_bf16 v[204:219], v[224:227], v[64:67], v[204:219]
    ds_read_b64_tr_b16 v[220:221], v245 offset:9216
    ds_read_b64_tr_b16 v[222:223], v245 offset:9472
    buffer_load_dwordx4 v233, s[28:31], s93 offen offset:1024 lds
    s_waitcnt lgkmcnt(6)
    v_mfma_f32_32x32x16_bf16 v[148:163], v[84:87], v[180:183], v[148:163]
    ds_read_b64_tr_b16 v[196:197], v243 offset:28672
    ds_read_b64_tr_b16 v[198:199], v243 offset:29184
    v_mfma_f32_32x32x16_bf16 v[164:179], v[84:87], v[184:187], v[164:179]
    ds_read_b64_tr_b16 v[200:201], v244 offset:28672
    ds_read_b64_tr_b16 v[202:203], v244 offset:29184
    buffer_load_dwordx4 v234, s[28:31], s93 offen offset:2048 lds
    v_mfma_f32_32x32x16_bf16 v[204:219], v[228:231], v[68:71], v[204:219]
    ds_read_b64_tr_b16 v[224:225], v245 offset:10240
    ds_read_b64_tr_b16 v[226:227], v245 offset:10496
    buffer_load_dwordx4 v235, s[28:31], s93 offen offset:3072 lds
    s_waitcnt lgkmcnt(6)
    v_mfma_f32_32x32x16_bf16 v[148:163], v[88:91], v[188:191], v[148:163]
    ds_read_b64_tr_b16 v[180:181], v243 offset:30720
    ds_read_b64_tr_b16 v[182:183], v243 offset:31232
    v_mfma_f32_32x32x16_bf16 v[164:179], v[88:91], v[192:195], v[164:179]
    ds_read_b64_tr_b16 v[184:185], v244 offset:30720
    ds_read_b64_tr_b16 v[186:187], v244 offset:31232
    v_mfma_f32_32x32x16_bf16 v[204:219], v[220:223], v[72:75], v[204:219]
    ds_read_b64_tr_b16 v[228:229], v245 offset:11264
    ds_read_b64_tr_b16 v[230:231], v245 offset:11520
    s_waitcnt lgkmcnt(6)
    s_waitcnt vmcnt(4)
    v_mfma_f32_32x32x16_bf16 v[148:163], v[92:95], v[196:199], v[148:163]
    ds_read_b128 v[100:103], v239 offset:0
    ds_read_b128 v[104:107], v240 offset:0
    ds_read_b128 v[108:111], v241 offset:0
    v_mfma_f32_32x32x16_bf16 v[164:179], v[92:95], v[200:203], v[164:179]
    ds_read_b128 v[112:115], v242 offset:0
    ds_read_b64_tr_b16 v[188:189], v243 offset:32768
    ds_read_b64_tr_b16 v[190:191], v243 offset:33280
    v_mfma_f32_32x32x16_bf16 v[204:219], v[224:227], v[76:79], v[204:219]
    ds_read_b64_tr_b16 v[192:193], v244 offset:32768
    ds_read_b64_tr_b16 v[194:195], v244 offset:33280
    ds_read_b64_tr_b16 v[220:221], v245 offset:12288
    s_waitcnt lgkmcnt(11)
    ds_read_b64_tr_b16 v[222:223], v245 offset:12544
    s_waitcnt lgkmcnt(6)
    v_mfma_f32_32x32x16_bf16 v[148:163], v[96:99], v[180:183], v[148:163]
    ds_read_b64_tr_b16 v[196:197], v243 offset:34816
    ds_read_b64_tr_b16 v[198:199], v243 offset:35328
    v_mfma_f32_32x32x16_bf16 v[164:179], v[96:99], v[184:187], v[164:179]
    ds_read_b64_tr_b16 v[200:201], v244 offset:34816
    ds_read_b64_tr_b16 v[202:203], v244 offset:35328
    s_add_u32 m0, s69, 0
    s_add_u32 s93, s54, s55
    buffer_load_dwordx4 v232, s[28:31], s93 offen lds
    s_add_u32 s54, s54, 128
    s_cmp_eq_u32 s54, 896
    s_cselect_b32 s54, 0, s54
    v_mfma_f32_32x32x16_bf16 v[204:219], v[228:231], v[80:83], v[204:219]
    ds_read_b64_tr_b16 v[224:225], v245 offset:13312
    ds_read_b64_tr_b16 v[226:227], v245 offset:13568
    buffer_load_dwordx4 v233, s[28:31], s93 offen offset:1024 lds
    s_waitcnt lgkmcnt(6)
    v_mfma_f32_32x32x16_bf16 v[148:163], v[100:103], v[188:191], v[148:163]
    ds_read_b64_tr_b16 v[180:181], v243 offset:36864
    ds_read_b64_tr_b16 v[182:183], v243 offset:37376
    v_mfma_f32_32x32x16_bf16 v[164:179], v[100:103], v[192:195], v[164:179]
    ds_read_b64_tr_b16 v[184:185], v244 offset:36864
    ds_read_b64_tr_b16 v[186:187], v244 offset:37376
    buffer_load_dwordx4 v234, s[28:31], s93 offen offset:2048 lds
    v_mfma_f32_32x32x16_bf16 v[204:219], v[220:223], v[84:87], v[204:219]
    ds_read_b64_tr_b16 v[228:229], v245 offset:14336
    ds_read_b64_tr_b16 v[230:231], v245 offset:14592
    buffer_load_dwordx4 v235, s[28:31], s93 offen offset:3072 lds
    s_waitcnt lgkmcnt(6)
    v_mfma_f32_32x32x16_bf16 v[148:163], v[104:107], v[196:199], v[148:163]
    ds_read_b64_tr_b16 v[188:189], v243 offset:38912
    ds_read_b64_tr_b16 v[190:191], v243 offset:39424
    v_mfma_f32_32x32x16_bf16 v[164:179], v[104:107], v[200:203], v[164:179]
    ds_read_b64_tr_b16 v[192:193], v244 offset:38912
    ds_read_b64_tr_b16 v[194:195], v244 offset:39424
    v_mfma_f32_32x32x16_bf16 v[204:219], v[224:227], v[88:91], v[204:219]
    ds_read_b64_tr_b16 v[220:221], v245 offset:15360
    ds_read_b64_tr_b16 v[222:223], v245 offset:15616
    s_waitcnt lgkmcnt(6)
    s_waitcnt vmcnt(4)
    v_mfma_f32_32x32x16_bf16 v[148:163], v[108:111], v[180:183], v[148:163]
    ds_read_b128 v[116:119], v239 offset:16384
    ds_read_b128 v[120:123], v240 offset:16384
    ds_read_b128 v[124:127], v241 offset:16384
    v_mfma_f32_32x32x16_bf16 v[164:179], v[108:111], v[184:187], v[164:179]
    ds_read_b128 v[128:131], v242 offset:16384
    ds_read_b64_tr_b16 v[196:197], v243 offset:40960
    ds_read_b64_tr_b16 v[198:199], v243 offset:41472
    v_mfma_f32_32x32x16_bf16 v[204:219], v[228:231], v[92:95], v[204:219]
    ds_read_b64_tr_b16 v[200:201], v244 offset:40960
    ds_read_b64_tr_b16 v[202:203], v244 offset:41472
    ds_read_b64_tr_b16 v[224:225], v245 offset:16384
    s_waitcnt lgkmcnt(11)
    ds_read_b64_tr_b16 v[226:227], v245 offset:16640
    s_waitcnt lgkmcnt(10)
    v_mfma_f32_32x32x16_bf16 v[148:163], v[112:115], v[188:191], v[148:163]
    ds_read_b64_tr_b16 v[180:181], v243 offset:43008
    ds_read_b64_tr_b16 v[182:183], v243 offset:43520
    v_mfma_f32_32x32x16_bf16 v[164:179], v[112:115], v[192:195], v[164:179]
    ds_read_b64_tr_b16 v[184:185], v244 offset:43008
    ds_read_b64_tr_b16 v[186:187], v244 offset:43520
    v_mfma_f32_32x32x16_bf16 v[204:219], v[220:223], v[96:99], v[204:219]
    ds_read_b64_tr_b16 v[228:229], v245 offset:17408
    s_waitcnt lgkmcnt(11)
    ds_read_b64_tr_b16 v[230:231], v245 offset:17664
    s_waitcnt lgkmcnt(6)
    v_mfma_f32_32x32x16_bf16 v[148:163], v[116:119], v[196:199], v[148:163]
    ds_read_b64_tr_b16 v[188:189], v243 offset:45056
    ds_read_b64_tr_b16 v[190:191], v243 offset:45568
    v_mfma_f32_32x32x16_bf16 v[164:179], v[116:119], v[200:203], v[164:179]
    ds_read_b64_tr_b16 v[192:193], v244 offset:45056
    ds_read_b64_tr_b16 v[194:195], v244 offset:45568
    v_mfma_f32_32x32x16_bf16 v[204:219], v[224:227], v[100:103], v[204:219]
    ds_read_b64_tr_b16 v[220:221], v245 offset:18432
    ds_read_b64_tr_b16 v[222:223], v245 offset:18688
    s_waitcnt lgkmcnt(6)
    v_mfma_f32_32x32x16_bf16 v[148:163], v[120:123], v[180:183], v[148:163]
    ds_read_b64_tr_b16 v[196:197], v243 offset:47104
    ds_read_b64_tr_b16 v[198:199], v243 offset:47616
    v_mfma_f32_32x32x16_bf16 v[164:179], v[120:123], v[184:187], v[164:179]
    ds_read_b64_tr_b16 v[200:201], v244 offset:47104
    ds_read_b64_tr_b16 v[202:203], v244 offset:47616
    v_mfma_f32_32x32x16_bf16 v[204:219], v[228:231], v[104:107], v[204:219]
    ds_read_b64_tr_b16 v[224:225], v245 offset:19456
    ds_read_b64_tr_b16 v[226:227], v245 offset:19712
    s_waitcnt lgkmcnt(6)
    s_waitcnt vmcnt(0)
    v_mfma_f32_32x32x16_bf16 v[148:163], v[124:127], v[188:191], v[148:163]
    ds_read_b128 v[132:135], v239 offset:0
    ds_read_b128 v[136:139], v240 offset:0
    ds_read_b128 v[140:143], v241 offset:0
    v_mfma_f32_32x32x16_bf16 v[164:179], v[124:127], v[192:195], v[164:179]
    ds_read_b128 v[144:147], v242 offset:0
    ds_read_b64_tr_b16 v[180:181], v243 offset:49152
    ds_read_b64_tr_b16 v[182:183], v243 offset:49664
    v_mfma_f32_32x32x16_bf16 v[204:219], v[220:223], v[108:111], v[204:219]
    ds_read_b64_tr_b16 v[184:185], v244 offset:49152
    ds_read_b64_tr_b16 v[186:187], v244 offset:49664
    ds_read_b64_tr_b16 v[228:229], v245 offset:20480
    s_waitcnt lgkmcnt(11)
    ds_read_b64_tr_b16 v[230:231], v245 offset:20736
    s_waitcnt lgkmcnt(10)
    v_mfma_f32_32x32x16_bf16 v[148:163], v[128:131], v[196:199], v[148:163]
    ds_read_b64_tr_b16 v[188:189], v243 offset:51200
    ds_read_b64_tr_b16 v[190:191], v243 offset:51712
    v_mfma_f32_32x32x16_bf16 v[164:179], v[128:131], v[200:203], v[164:179]
    ds_read_b64_tr_b16 v[192:193], v244 offset:51200
    ds_read_b64_tr_b16 v[194:195], v244 offset:51712
    v_mfma_f32_32x32x16_bf16 v[204:219], v[224:227], v[112:115], v[204:219]
    ds_read_b64_tr_b16 v[220:221], v245 offset:21504
    s_waitcnt lgkmcnt(11)
    ds_read_b64_tr_b16 v[222:223], v245 offset:21760
    s_waitcnt lgkmcnt(6)
    v_mfma_f32_32x32x16_bf16 v[148:163], v[132:135], v[180:183], v[148:163]
    ds_read_b64_tr_b16 v[196:197], v243 offset:53248
    ds_read_b64_tr_b16 v[198:199], v243 offset:53760
    v_mfma_f32_32x32x16_bf16 v[164:179], v[132:135], v[184:187], v[164:179]
    ds_read_b64_tr_b16 v[200:201], v244 offset:53248
    ds_read_b64_tr_b16 v[202:203], v244 offset:53760
    v_mfma_f32_32x32x16_bf16 v[204:219], v[228:231], v[116:119], v[204:219]
    ds_read_b64_tr_b16 v[224:225], v245 offset:22528
    ds_read_b64_tr_b16 v[226:227], v245 offset:22784
    buffer_store_dwordx4 v[252:255], v250, s[36:39], s92 offen offset:0 sc1
    s_waitcnt lgkmcnt(6)
    v_mfma_f32_32x32x16_bf16 v[148:163], v[136:139], v[188:191], v[148:163]
    ds_read_b64_tr_b16 v[180:181], v243 offset:55296
    ds_read_b64_tr_b16 v[182:183], v243 offset:55808
    v_mfma_f32_32x32x16_bf16 v[164:179], v[136:139], v[192:195], v[164:179]
    ds_read_b64_tr_b16 v[184:185], v244 offset:55296
    ds_read_b64_tr_b16 v[186:187], v244 offset:55808
    v_mfma_f32_32x32x16_bf16 v[204:219], v[220:223], v[120:123], v[204:219]
    ds_read_b64_tr_b16 v[228:229], v245 offset:23552
    ds_read_b64_tr_b16 v[230:231], v245 offset:23808
    s_waitcnt lgkmcnt(6)
    v_mfma_f32_32x32x16_bf16 v[148:163], v[140:143], v[196:199], v[148:163]
    v_mfma_f32_32x32x16_bf16 v[164:179], v[140:143], v[200:203], v[164:179]
    ds_read_b64_tr_b16 v[220:221], v245 offset:24576
    v_mfma_f32_32x32x16_bf16 v[204:219], v[224:227], v[124:127], v[204:219]
    ds_read_b64_tr_b16 v[222:223], v245 offset:24832
    s_waitcnt lgkmcnt(2)
    v_mfma_f32_32x32x16_bf16 v[148:163], v[144:147], v[180:183], v[148:163]
    v_mfma_f32_32x32x16_bf16 v[164:179], v[144:147], v[184:187], v[164:179]
    ds_read_b64_tr_b16 v[224:225], v245 offset:25600
    v_mfma_f32_32x32x16_bf16 v[204:219], v[228:231], v[128:131], v[204:219]
    ds_read_b64_tr_b16 v[226:227], v245 offset:25856
    s_waitcnt lgkmcnt(2)
    v_mfma_f32_32x32x16_bf16 v[204:219], v[220:223], v[132:135], v[204:219]
    ds_read_b64_tr_b16 v[228:229], v245 offset:26624
    ds_read_b64_tr_b16 v[230:231], v245 offset:26880
    s_waitcnt lgkmcnt(2)
    v_mfma_f32_32x32x16_bf16 v[204:219], v[224:227], v[136:139], v[204:219]
    ds_read_b64_tr_b16 v[220:221], v245 offset:27648
    ds_read_b64_tr_b16 v[222:223], v245 offset:27904
    v_cvt_pk_bf16_f32 v180, v148, v149
    v_cvt_pk_bf16_f32 v181, v150, v151
    v_cvt_pk_bf16_f32 v182, v152, v153
    v_cvt_pk_bf16_f32 v183, v154, v155
    v_cvt_pk_bf16_f32 v184, v156, v157
    v_cvt_pk_bf16_f32 v185, v158, v159
    s_mov_b64 exec, 0xffff
    buffer_load_dword v34, v17, s[36:39], s5 offen sc1
    s_mov_b64 exec, -1
    s_waitcnt lgkmcnt(2)
    v_mfma_f32_32x32x16_bf16 v[204:219], v[228:231], v[140:143], v[204:219]
    v_cvt_pk_bf16_f32 v186, v160, v161
    v_cvt_pk_bf16_f32 v187, v162, v163
    v_cvt_pk_bf16_f32 v188, v164, v165
    v_cvt_pk_bf16_f32 v189, v166, v167
    v_cvt_pk_bf16_f32 v190, v168, v169
    s_waitcnt lgkmcnt(0)
    v_mfma_f32_32x32x16_bf16 v[204:219], v[220:223], v[144:147], v[204:219]
    v_cvt_pk_bf16_f32 v191, v170, v171
    v_cvt_pk_bf16_f32 v192, v172, v173
    v_cvt_pk_bf16_f32 v193, v174, v175
    v_cvt_pk_bf16_f32 v194, v176, v177
    v_cvt_pk_bf16_f32 v195, v178, v179
    s_nop 6
    v_pk_mul_f32 v[204:205], v[204:205], s[90:91]
    v_pk_mul_f32 v[206:207], v[206:207], s[90:91]
    v_pk_mul_f32 v[208:209], v[208:209], s[90:91]
    v_pk_mul_f32 v[210:211], v[210:211], s[90:91]
    v_pk_mul_f32 v[212:213], v[212:213], s[90:91]
    v_pk_mul_f32 v[214:215], v[214:215], s[90:91]
    v_pk_mul_f32 v[216:217], v[216:217], s[90:91]
    v_pk_mul_f32 v[218:219], v[218:219], s[90:91]
    v_cvt_pk_bf16_f32 v196, v204, v205
    v_cvt_pk_bf16_f32 v197, v206, v207
    v_cvt_pk_bf16_f32 v198, v208, v209
    v_cvt_pk_bf16_f32 v199, v210, v211
    v_cvt_pk_bf16_f32 v200, v212, v213
    v_cvt_pk_bf16_f32 v201, v214, v215
    v_cvt_pk_bf16_f32 v202, v216, v217
    v_cvt_pk_bf16_f32 v203, v218, v219
    v_mov_b32 v10, 16640
    v_cndmask_b32 v203, 0, v203, s[64:65]
    v_cndmask_b32 v202, v10, v202, s[64:65]
    ds_write_b128 v12, v[196:199]
    ds_write_b128 v12, v[200:203] offset:1024
    s_waitcnt lgkmcnt(0)
    s_branch L_b0
L_yN:
    s_mov_b64 exec, 1
    buffer_store_dword v31, v3, s[36:39], s79 offen offset:0 sc1
    s_mov_b64 exec, -1
    s_add_u32 m0, s7, 0
    s_add_u32 s94, s3, s70
    buffer_load_dwordx4 v238, s[32:35], s94 offen lds
    s_add_u32 s3, s3, 172032
    s_cmp_eq_u32 s3, 1204224
    s_cselect_b32 s3, 0, s3
    s_add_u32 m0, s7, 4096
    s_add_u32 s94, s3, s70
    buffer_load_dwordx4 v238, s[32:35], s94 offen lds
    s_add_u32 s3, s3, 172032
    s_cmp_eq_u32 s3, 1204224
    s_cselect_b32 s3, 0, s3
    s_add_u32 m0, s7, 8192
    s_add_u32 s94, s3, s70
    buffer_load_dwordx4 v238, s[32:35], s94 offen lds
    s_add_u32 s3, s3, 172032
    s_cmp_eq_u32 s3, 1204224
    s_cselect_b32 s3, 0, s3
    s_add_u32 m0, s7, 12288
    s_add_u32 s94, s3, s70
    buffer_load_dwordx4 v238, s[32:35], s94 offen lds
    s_add_u32 s3, s3, 172032
    s_cmp_eq_u32 s3, 1204224
    s_cselect_b32 s3, 0, s3
    s_add_u32 m0, s7, 16384
    s_add_u32 s94, s3, s70
    buffer_load_dwordx4 v238, s[32:35], s94 offen lds
    s_add_u32 s3, s3, 172032
    s_cmp_eq_u32 s3, 1204224
    s_cselect_b32 s3, 0, s3
    s_add_u32 m0, s7, 20480
    s_add_u32 s94, s3, s70
    buffer_load_dwordx4 v238, s[32:35], s94 offen lds
    s_add_u32 s3, s3, 172032
    s_cmp_eq_u32 s3, 1204224
    s_cselect_b32 s3, 0, s3
    s_add_u32 m0, s7, 24576
    s_add_u32 s94, s3, s70
    buffer_load_dwordx4 v238, s[32:35], s94 offen lds
    s_add_u32 s3, s3, 172032
    s_cmp_eq_u32 s3, 1204224
    s_cselect_b32 s3, 0, s3
    s_lshl_b32 s5, s49, 6
    s_and_b32 s61, s48, 3
    s_add_u32 s5, s5, s61
    s_mul_i32 s5, s5, 2048
    s_add_u32 s5, s5, 13631488
    s_lshl_b32 s60, s50, 1
    s_add_u32 s60, s60, s78
    s_and_b32 s60, s60, 7
    s_lshl_b32 s72, s60, 15
    s_lshl_b32 s61, s61, 12
    s_add_u32 s72, s72, s61
    v_bfe_u32 v8, v1, 2, 2
    v_lshl_add_u32 v8, v8, 1, s60
    v_lshrrev_b32 v6, 5, v1
    v_add_u32 v8, v8, v6
    v_and_b32 v8, 7, v8
    v_bfe_u32 v6, v1, 4, 1
    v_lshl_add_u32 v8, v8, 1, v6
    v_mul_u32_u24 v8, 8192, v8
    s_mul_i32 s60, s50, 28
    s_add_u32 s61, s60, 27
    s_lshr_b32 s60, s60, 6
    s_lshr_b32 s61, s61, 6
    s_sub_u32 s61, s61, s60
    v_and_b32 v5, 1, v1
    v_mul_u32_u24 v5, s61, v5
    v_add_u32 v5, s60, v5
    v_bfe_u32 v6, v1, 1, 1
    v_mad_u32_u24 v5, v6, 7, v5
    v_add_u32 v9, 10, v5
    v_lshrrev_b32 v9, 4, v9
    v_lshrrev_b32 v7, 3, v5
    v_add3_u32 v5, v5, v9, v7
    s_sub_u32 s62, s61, 1
    s_and_b32 s62, s62, 0xaaaaaaaa
    s_mov_b32 s63, s62
    v_mad_u32_u24 v6, v6, 3, 6
    v_cndmask_b32 v5, v5, v6, s[62:63]
    v_lshl_add_u32 v17, v5, 7, v8
    s_lshl_b32 s68, s74, 18
    s_add_u32 s68, s68, 1048576
    s_mov_b32 s84, s78
    s_mov_b32 s64, -1
    s_mov_b32 s65, 0
    s_mov_b32 s90, 0x3e8b97f6
    s_mov_b32 s91, 0x3e8b97f6
    s_and_b32 s61, s48, 3
    v_mov_b32 v4, 0xdddddddd
    s_or_b32 s62, s61, 1
    s_add_u32 s60, s61, s62
    s_lshl_b32 s60, s60, 11
    s_add_u32 s60, s60, 65536
    s_lshl_b32 s62, s61, 11
    s_add_u32 s62, s62, 155648
    s_sub_u32 s60, s60, s62
    s_mul_i32 s60, s60, s78
    s_add_u32 s60, s60, s62
    v_and_b32 v5, 1, v1
    v_lshlrev_b32 v5, 4, v5
    v_bfe_u32 v6, v1, 4, 1
    v_lshl_add_u32 v5, v6, 3, v5
    v_bfe_u32 v6, v1, 3, 1
    v_lshl_add_u32 v5, v6, 1, v5
    v_bfe_u32 v6, v1, 1, 1
    v_add_u32 v5, v5, v6
    v_and_b32 v6, 0x24, v1
    v_add_u32 v5, v5, v6
    v_sub_u32 v5, v5, v1
    v_mul_lo_u32 v5, v5, s67
    v_add_u32 v5, v5, v1
    v_lshl_add_u32 v12, v5, 4, s60
    s_lshr_b32 s63, s61, 1
    s_and_b32 s62, s61, 1
    s_add_u32 s60, s63, 12
    s_lshl_b32 s62, s62, s60
    s_mul_i32 s63, s63, 4294879232
    s_add_u32 s62, s62, s63
    s_add_u32 s62, s62, 155648
    s_lshl_b32 s60, s78, 11
    s_sub_u32 s63, s62, s60
    s_add_u32 s62, s62, s60
    v_add_u32 v13, s63, v3
    v_add_u32 v29, s62, v3
    s_lshl_b32 s60, s78, 14
    v_add_u32 v14, s60, v3
    v_add_u32 v15, 0x10000, v14
    v_lshl_add_u32 v19, v1, 3, s60
    s_mov_b32 s42, 401408
    s_mov_b32 s43, 0x20000
    s_mov_b32 s44, s20
    s_mov_b32 s45, s21
    s_mov_b32 s46, 3670016
    s_mov_b32 s47, 0x20000
    s_mov_b32 s89, 1006632960
    s_and_b32 s77, s50, 3
    s_mul_i32 s77, s77, 224
    s_lshl_b32 s61, s49, 3
    s_add_u32 s61, s61, s51
    s_lshl_b32 s61, s61, 3
    s_lshr_b32 s60, s50, 2
    s_bfe_u32 s62, s48, 0x10001
    s_lshl_b32 s87, s62, 2
    s_add_u32 s87, s87, s60
    s_add_u32 s87, s87, s61
    s_mul_i32 s87, s87, 2048
    s_add_u32 s87, s87, 13631552
    s_lshl_b32 s63, s60, 1
    s_add_u32 s63, s63, s62
    s_add_u32 s63, s63, s61
    s_lshl_b32 s86, s63, 15
    s_add_u32 s86, s86, 9437184
    s_and_b32 s63, s48, 1
    s_lshl_b32 s63, s63, 8
    s_add_u32 s86, s86, s63
    s_lshl_b32 s63, s78, 11
    s_add_u32 s86, s86, s63
    s_lshl_b32 s61, s51, 2
    s_add_u32 s60, s60, s61
    s_lshl_b32 s60, s60, 2
    s_and_b32 s61, s48, 3
    s_add_u32 s60, s60, s61
    s_mul_i32 s88, s60, 28672
    s_mul_i32 s60, s49, 896
    s_add_u32 s88, s88, s60
    s_add_u32 s88, s88, s77
    v_and_b32 v7, 7, v1
    s_add_u32 s60, s61, 5
    s_lshl_b32 s60, s60, 13
    s_and_b32 s60, s60, 0xffff
    v_add_u32 v24, s60, v3
    s_lshl_b32 s62, s61, 2
    s_add_u32 s62, s62, 161280
    v_mov_b32 v25, s62
    s_mul_i32 s62, s61, 3072
    s_add_u32 s62, s62, 16384
    v_add_u32 v23, s62, v3
    v_lshrrev_b32 v6, 3, v1
    s_lshl_b32 s62, s78, 11
    s_add_u32 s60, s60, s62
    s_add_u32 s60, s60, 4096
    v_xor_b32 v8, v6, v7
    v_lshlrev_b32 v8, 4, v8
    v_lshl_add_u32 v8, v6, 7, v8
    v_add_u32 v27, s60, v8
    s_and_b32 s9, s50, 3
    s_lshl_b32 s9, s9, 1
    s_lshl_b32 s62, s78, 3
    s_add_u32 s62, s62, s9
    v_add_u32 v9, s62, v7
    v_subrev_u32 v8, 14, v9
    v_min_u32 v9, v9, v8
    v_mul_u32_u24 v8, 1792, v6
    v_lshl_add_u32 v28, v9, 4, v8
    v_add_u32 v8, 2, v7
    v_lshrrev_b32 v8, 3, v8
    v_mul_u32_u24 v8, s78, v8
    v_lshl_add_u32 v28, v8, 30, v28
    v_and_b32 v5, 15, v1
    v_lshrrev_b32 v6, 4, v1
    v_lshrrev_b32 v8, 1, v6
    v_xor_b32 v8, v8, v7
    v_lshlrev_b32 v8, 4, v8
    v_lshl_add_u32 v8, v5, 7, v8
    v_and_b32 v9, 1, v6
    v_lshl_add_u32 v8, v9, 3, v8
    v_add_u32 v26, s60, v8
    v_lshlrev_b32 v18, 7, v5
    v_lshlrev_b32 v7, 12, v7
    v_add_u32 v30, 1776, v7
    v_lshlrev_b32 v7, 9, v6
    v_lshl_add_u32 v20, v5, 4, v7
    v_lshrrev_b32 v7, 1, v6
    v_lshlrev_b32 v7, 4, v7
    v_lshl_add_u32 v7, v9, 2, v7
    v_bfe_u32 v8, v1, 2, 2
    v_add_u32 v7, v7, v8
    v_mul_u32_u24 v7, 224, v7
    v_and_b32 v8, 3, v1
    v_lshl_add_u32 v7, v8, 3, v7
    v_add_u32 v8, 1, v6
    v_lshrrev_b32 v8, 2, v8
    v_mul_u32_u24 v8, 896, v8
    v_sub_u32 v8, v7, v8
    s_mul_i32 s60, s78, 6272
    s_add_u32 s60, s60, 66944
    v_add_u32 v21, s60, v7
    s_add_u32 s60, s60, 1792
    v_add_u32 v22, s60, v8
    s_mul_i32 s13, s78, 4294839040
    s_add_u32 s13, s13, 87808
    v_mul_u32_u24 v7, 0x4925, v1
    v_lshrrev_b32 v7, 18, v7
    v_mul_u32_u24 v8, 14, v7
    v_sub_u32 v8, v1, v8
    v_add_u32 v8, s9, v8
    v_subrev_u32 v9, 14, v8
    v_min_u32 v8, v8, v9
    v_mul_u32_u24 v7, 896, v7
    v_lshl_add_u32 v16, v8, 4, v7
    s_mul_i32 s73, s48, 3584
    s_add_u32 s73, s73, s77
    s_mul_i32 s26, s48, 896
    s_add_u32 s27, s26, 31872
    s_max_u32 s60, s48, 1
    s_sub_u32 s60, s60, s48
    s_mul_i32 s60, s60, 128256
    s_add_u32 s27, s27, s60
    v_mov_b32 v246, 1073741824
    v_mov_b32 v247, 1073741824
    v_mov_b32 v248, 1073741824
    v_mov_b32 v249, 1073741824
    s_waitcnt vmcnt(12)
    ds_read_b128 v[36:39], v239 offset:0
    ds_read_b128 v[40:43], v240 offset:0
    ds_read_b128 v[44:47], v241 offset:0
    ds_read_b128 v[48:51], v242 offset:0
    s_waitcnt lgkmcnt(0)
    s_add_u32 m0, s69, 0
    s_add_u32 s93, s54, s55
    buffer_load_dwordx4 v232, s[28:31], s93 offen lds
    s_add_u32 s54, s54, 128
    s_cmp_eq_u32 s54, 896
    s_cselect_b32 s54, 0, s54
    buffer_load_dwordx4 v233, s[28:31], s93 offen offset:1024 lds
    buffer_load_dwordx4 v234, s[28:31], s93 offen offset:2048 lds
    buffer_load_dwordx4 v235, s[28:31], s93 offen offset:3072 lds
    s_waitcnt vmcnt(12)
    ds_read_b128 v[52:55], v239 offset:16384
    ds_read_b128 v[56:59], v240 offset:16384
    ds_read_b128 v[60:63], v241 offset:16384
    ds_read_b128 v[64:67], v242 offset:16384
    s_waitcnt lgkmcnt(0)
    s_add_u32 m0, s69, 16384
    s_add_u32 s93, s54, s55
    buffer_load_dwordx4 v232, s[28:31], s93 offen lds
    s_add_u32 s54, s54, 128
    s_cmp_eq_u32 s54, 896
    s_cselect_b32 s54, 0, s54
    buffer_load_dwordx4 v233, s[28:31], s93 offen offset:1024 lds
    buffer_load_dwordx4 v234, s[28:31], s93 offen offset:2048 lds
    buffer_load_dwordx4 v235, s[28:31], s93 offen offset:3072 lds
    s_waitcnt vmcnt(4)
    ds_read_b128 v[68:71], v239 offset:0
    ds_read_b128 v[72:75], v240 offset:0
    ds_read_b128 v[76:79], v241 offset:0
    ds_read_b128 v[80:83], v242 offset:0
    s_waitcnt lgkmcnt(0)
    s_add_u32 m0, s69, 0
    s_add_u32 s93, s54, s55
    buffer_load_dwordx4 v232, s[28:31], s93 offen lds
    s_add_u32 s54, s54, 128
    s_cmp_eq_u32 s54, 896
    s_cselect_b32 s54, 0, s54
    buffer_load_dwordx4 v233, s[28:31], s93 offen offset:1024 lds
    buffer_load_dwordx4 v234, s[28:31], s93 offen offset:2048 lds
    buffer_load_dwordx4 v235, s[28:31], s93 offen offset:3072 lds
    s_waitcnt vmcnt(4)
    ds_read_b128 v[84:87], v239 offset:16384
    ds_read_b128 v[88:91], v240 offset:16384
    ds_read_b128 v[92:95], v241 offset:16384
    ds_read_b128 v[96:99], v242 offset:16384
    s_waitcnt lgkmcnt(0)
    s_add_u32 m0, s69, 16384
    s_add_u32 s93, s54, s55
    buffer_load_dwordx4 v232, s[28:31], s93 offen lds
    s_add_u32 s54, s54, 128
    s_cmp_eq_u32 s54, 896
    s_cselect_b32 s54, 0, s54
    buffer_load_dwordx4 v233, s[28:31], s93 offen offset:1024 lds
    buffer_load_dwordx4 v234, s[28:31], s93 offen offset:2048 lds
    buffer_load_dwordx4 v235, s[28:31], s93 offen offset:3072 lds
    s_waitcnt vmcnt(4)
    ds_read_b128 v[100:103], v239 offset:0
    ds_read_b128 v[104:107], v240 offset:0
    ds_read_b128 v[108:111], v241 offset:0
    ds_read_b128 v[112:115], v242 offset:0
    s_waitcnt lgkmcnt(0)
    s_add_u32 m0, s69, 0
    s_add_u32 s93, s54, s55
    buffer_load_dwordx4 v232, s[28:31], s93 offen lds
    s_add_u32 s54, s54, 128
    s_cmp_eq_u32 s54, 896
    s_cselect_b32 s54, 0, s54
    buffer_load_dwordx4 v233, s[28:31], s93 offen offset:1024 lds
    buffer_load_dwordx4 v234, s[28:31], s93 offen offset:2048 lds
    buffer_load_dwordx4 v235, s[28:31], s93 offen offset:3072 lds
    s_waitcnt vmcnt(4)
    ds_read_b128 v[116:119], v239 offset:16384
    ds_read_b128 v[120:123], v240 offset:16384
    ds_read_b128 v[124:127], v241 offset:16384
    ds_read_b128 v[128:131], v242 offset:16384
    s_waitcnt lgkmcnt(0)
    s_waitcnt vmcnt(0)
    ds_read_b128 v[132:135], v239 offset:0
    ds_read_b128 v[136:139], v240 offset:0
    ds_read_b128 v[140:143], v241 offset:0
    ds_read_b128 v[144:147], v242 offset:0
    s_waitcnt lgkmcnt(0)
    s_barrier
    ds_read_b64_tr_b16 v[220:221], v245 offset:0
    ds_read_b64_tr_b16 v[222:223], v245 offset:256
    ds_read_b64_tr_b16 v[224:225], v245 offset:1024
    ds_read_b64_tr_b16 v[226:227], v245 offset:1280
    s_waitcnt lgkmcnt(2)
    v_mfma_f32_32x32x16_bf16 v[204:219], v[220:223], v[36:39], 0
    ds_read_b64_tr_b16 v[228:229], v245 offset:2048
    ds_read_b64_tr_b16 v[230:231], v245 offset:2304
    s_waitcnt lgkmcnt(2)
    v_mfma_f32_32x32x16_bf16 v[204:219], v[224:227], v[40:43], v[204:219]
    ds_read_b64_tr_b16 v[220:221], v245 offset:3072
    ds_read_b64_tr_b16 v[222:223], v245 offset:3328
    s_waitcnt lgkmcnt(2)
    v_mfma_f32_32x32x16_bf16 v[204:219], v[228:231], v[44:47], v[204:219]
    ds_read_b64_tr_b16 v[224:225], v245 offset:4096
    ds_read_b64_tr_b16 v[226:227], v245 offset:4352
    s_waitcnt lgkmcnt(2)
    v_mfma_f32_32x32x16_bf16 v[204:219], v[220:223], v[48:51], v[204:219]
    ds_read_b64_tr_b16 v[228:229], v245 offset:5120
    ds_read_b64_tr_b16 v[230:231], v245 offset:5376
    s_waitcnt lgkmcnt(2)
    v_mfma_f32_32x32x16_bf16 v[204:219], v[224:227], v[52:55], v[204:219]
    ds_read_b64_tr_b16 v[220:221], v245 offset:6144
    ds_read_b64_tr_b16 v[222:223], v245 offset:6400
    s_waitcnt lgkmcnt(2)
    v_mfma_f32_32x32x16_bf16 v[204:219], v[228:231], v[56:59], v[204:219]
    ds_read_b64_tr_b16 v[224:225], v245 offset:7168
    ds_read_b64_tr_b16 v[226:227], v245 offset:7424
    s_waitcnt lgkmcnt(2)
    v_mfma_f32_32x32x16_bf16 v[204:219], v[220:223], v[60:63], v[204:219]
    ds_read_b64_tr_b16 v[228:229], v245 offset:8192
    ds_read_b64_tr_b16 v[230:231], v245 offset:8448
    s_waitcnt lgkmcnt(2)
    v_mfma_f32_32x32x16_bf16 v[204:219], v[224:227], v[64:67], v[204:219]
    ds_read_b64_tr_b16 v[220:221], v245 offset:9216
    ds_read_b64_tr_b16 v[222:223], v245 offset:9472
    s_waitcnt lgkmcnt(2)
    v_mfma_f32_32x32x16_bf16 v[204:219], v[228:231], v[68:71], v[204:219]
    ds_read_b64_tr_b16 v[224:225], v245 offset:10240
    ds_read_b64_tr_b16 v[226:227], v245 offset:10496
    s_waitcnt lgkmcnt(2)
    v_mfma_f32_32x32x16_bf16 v[204:219], v[220:223], v[72:75], v[204:219]
    ds_read_b64_tr_b16 v[228:229], v245 offset:11264
    ds_read_b64_tr_b16 v[230:231], v245 offset:11520
    s_waitcnt lgkmcnt(2)
    v_mfma_f32_32x32x16_bf16 v[204:219], v[224:227], v[76:79], v[204:219]
    ds_read_b64_tr_b16 v[220:221], v245 offset:12288
    ds_read_b64_tr_b16 v[222:223], v245 offset:12544
    s_waitcnt lgkmcnt(2)
    v_mfma_f32_32x32x16_bf16 v[204:219], v[228:231], v[80:83], v[204:219]
    ds_read_b64_tr_b16 v[224:225], v245 offset:13312
    ds_read_b64_tr_b16 v[226:227], v245 offset:13568
    s_waitcnt lgkmcnt(2)
    v_mfma_f32_32x32x16_bf16 v[204:219], v[220:223], v[84:87], v[204:219]
    ds_read_b64_tr_b16 v[228:229], v245 offset:14336
    ds_read_b64_tr_b16 v[230:231], v245 offset:14592
    s_waitcnt lgkmcnt(2)
    v_mfma_f32_32x32x16_bf16 v[204:219], v[224:227], v[88:91], v[204:219]
    ds_read_b64_tr_b16 v[220:221], v245 offset:15360
    ds_read_b64_tr_b16 v[222:223], v245 offset:15616
    s_waitcnt lgkmcnt(2)
    v_mfma_f32_32x32x16_bf16 v[204:219], v[228:231], v[92:95], v[204:219]
    ds_read_b64_tr_b16 v[224:225], v245 offset:16384
    ds_read_b64_tr_b16 v[226:227], v245 offset:16640
    s_waitcnt lgkmcnt(2)
    v_mfma_f32_32x32x16_bf16 v[204:219], v[220:223], v[96:99], v[204:219]
    ds_read_b64_tr_b16 v[228:229], v245 offset:17408
    ds_read_b64_tr_b16 v[230:231], v245 offset:17664
    s_waitcnt lgkmcnt(2)
    v_mfma_f32_32x32x16_bf16 v[204:219], v[224:227], v[100:103], v[204:219]
    ds_read_b64_tr_b16 v[220:221], v245 offset:18432
    ds_read_b64_tr_b16 v[222:223], v245 offset:18688
    s_waitcnt lgkmcnt(2)
    v_mfma_f32_32x32x16_bf16 v[204:219], v[228:231], v[104:107], v[204:219]
    ds_read_b64_tr_b16 v[224:225], v245 offset:19456
    ds_read_b64_tr_b16 v[226:227], v245 offset:19712
    s_waitcnt lgkmcnt(2)
    v_mfma_f32_32x32x16_bf16 v[204:219], v[220:223], v[108:111], v[204:219]
    ds_read_b64_tr_b16 v[228:229], v245 offset:20480
    ds_read_b64_tr_b16 v[230:231], v245 offset:20736
    s_waitcnt lgkmcnt(2)
    v_mfma_f32_32x32x16_bf16 v[204:219], v[224:227], v[112:115], v[204:219]
    ds_read_b64_tr_b16 v[220:221], v245 offset:21504
    ds_read_b64_tr_b16 v[222:223], v245 offset:21760
    s_waitcnt lgkmcnt(2)
    v_mfma_f32_32x32x16_bf16 v[204:219], v[228:231], v[116:119], v[204:219]
    ds_read_b64_tr_b16 v[224:225], v245 offset:22528
    ds_read_b64_tr_b16 v[226:227], v245 offset:22784
    s_waitcnt lgkmcnt(2)
    v_mfma_f32_32x32x16_bf16 v[204:219], v[220:223], v[120:123], v[204:219]
    ds_read_b64_tr_b16 v[228:229], v245 offset:23552
    ds_read_b64_tr_b16 v[230:231], v245 offset:23808
    s_waitcnt lgkmcnt(2)
    v_mfma_f32_32x32x16_bf16 v[204:219], v[224:227], v[124:127], v[204:219]
    ds_read_b64_tr_b16 v[220:221], v245 offset:24576
    ds_read_b64_tr_b16 v[222:223], v245 offset:24832
    s_waitcnt lgkmcnt(2)
    v_mfma_f32_32x32x16_bf16 v[204:219], v[228:231], v[128:131], v[204:219]
    ds_read_b64_tr_b16 v[224:225], v245 offset:25600
    ds_read_b64_tr_b16 v[226:227], v245 offset:25856
    s_waitcnt lgkmcnt(2)
    v_mfma_f32_32x32x16_bf16 v[204:219], v[220:223], v[132:135], v[204:219]
    ds_read_b64_tr_b16 v[228:229], v245 offset:26624
    ds_read_b64_tr_b16 v[230:231], v245 offset:26880
    s_waitcnt lgkmcnt(2)
    v_mfma_f32_32x32x16_bf16 v[204:219], v[224:227], v[136:139], v[204:219]
    ds_read_b64_tr_b16 v[220:221], v245 offset:27648
    ds_read_b64_tr_b16 v[222:223], v245 offset:27904
    s_mov_b64 exec, 0xffff
    buffer_load_dword v34, v17, s[36:39], s5 offen sc1
    s_mov_b64 exec, -1
    s_waitcnt lgkmcnt(2)
    v_mfma_f32_32x32x16_bf16 v[204:219], v[228:231], v[140:143], v[204:219]
    s_waitcnt lgkmcnt(0)
    v_mfma_f32_32x32x16_bf16 v[204:219], v[220:223], v[144:147], v[204:219]
    s_nop 2
    s_nop 6
    s_nop 1
    v_pk_mul_f32 v[204:205], v[204:205], s[90:91]
    v_pk_mul_f32 v[206:207], v[206:207], s[90:91]
    v_pk_mul_f32 v[208:209], v[208:209], s[90:91]
    v_pk_mul_f32 v[210:211], v[210:211], s[90:91]
    v_pk_mul_f32 v[212:213], v[212:213], s[90:91]
    v_pk_mul_f32 v[214:215], v[214:215], s[90:91]
    v_pk_mul_f32 v[216:217], v[216:217], s[90:91]
    v_pk_mul_f32 v[218:219], v[218:219], s[90:91]
    v_cvt_pk_bf16_f32 v196, v204, v205
    v_cvt_pk_bf16_f32 v197, v206, v207
    v_cvt_pk_bf16_f32 v198, v208, v209
    v_cvt_pk_bf16_f32 v199, v210, v211
    v_cvt_pk_bf16_f32 v200, v212, v213
    v_cvt_pk_bf16_f32 v201, v214, v215
    v_cvt_pk_bf16_f32 v202, v216, v217
    v_cvt_pk_bf16_f32 v203, v218, v219
    v_mov_b32 v10, 16640
    v_cndmask_b32 v203, 0, v203, s[64:65]
    v_cndmask_b32 v202, v10, v202, s[64:65]
    ds_write_b128 v12, v[196:199]
    ds_write_b128 v12, v[200:203] offset:1024
    s_waitcnt lgkmcnt(0)
    s_branch L_b0
L_old:
    s_cmp_eq_u32 s100, 1
    s_cbranch_scc1 L_oN
    s_cmp_eq_u32 s67, 1
    s_cbranch_scc1 L_oV
    s_waitcnt vmcnt(4)
    ds_read_b128 v[36:39], v239 offset:0
    ds_read_b128 v[40:43], v240 offset:0
    ds_read_b128 v[44:47], v241 offset:0
    ds_read_b128 v[48:51], v242 offset:0
    s_waitcnt lgkmcnt(0)
    s_add_u32 m0, s69, 0
    s_add_u32 s93, s54, s55
    buffer_load_dwordx4 v232, s[28:31], s93 offen lds
    s_add_u32 s54, s54, 128
    s_cmp_eq_u32 s54, 896
    s_cselect_b32 s54, 0, s54
    buffer_load_dwordx4 v233, s[28:31], s93 offen offset:1024 lds
    buffer_load_dwordx4 v234, s[28:31], s93 offen offset:2048 lds
    buffer_load_dwordx4 v235, s[28:31], s93 offen offset:3072 lds
    s_barrier
    ds_read_b64_tr_b16 v[180:181], v243 offset:0
    ds_read_b64_tr_b16 v[182:183], v243 offset:512
    ds_read_b64_tr_b16 v[184:185], v244 offset:0
    ds_read_b64_tr_b16 v[186:187], v244 offset:512
    ds_read_b64_tr_b16 v[188:189], v243 offset:2048
    ds_read_b64_tr_b16 v[190:191], v243 offset:2560
    ds_read_b64_tr_b16 v[192:193], v244 offset:2048
    ds_read_b64_tr_b16 v[194:195], v244 offset:2560
    s_waitcnt lgkmcnt(4)
    s_waitcnt vmcnt(4)
    v_mfma_f32_32x32x16_bf16 v[148:163], v[180:183], v[36:39], 0
    ds_read_b128 v[52:55], v239 offset:16384
    ds_read_b128 v[56:59], v240 offset:16384
    ds_read_b128 v[60:63], v241 offset:16384
    ds_read_b128 v[64:67], v242 offset:16384
    v_and_b32 v5, 15, v1
    v_lshlrev_b32 v5, 4, v5
    v_mfma_f32_32x32x16_bf16 v[164:179], v[184:187], v[36:39], 0
    ds_read_b64_tr_b16 v[196:197], v243 offset:4096
    ds_read_b64_tr_b16 v[198:199], v243 offset:4608
    ds_read_b64_tr_b16 v[200:201], v244 offset:4096
    ds_read_b64_tr_b16 v[202:203], v244 offset:4608
    v_bfe_u32 v6, v1, 4, 1
    v_lshrrev_b32 v9, 5, v1
    s_waitcnt lgkmcnt(4)
    v_mfma_f32_32x32x16_bf16 v[148:163], v[188:191], v[40:43], v[148:163]
    ds_read_b64_tr_b16 v[180:181], v243 offset:6144
    ds_read_b64_tr_b16 v[182:183], v243 offset:6656
    s_add_u32 m0, s69, 16384
    s_add_u32 s93, s54, s55
    buffer_load_dwordx4 v232, s[28:31], s93 offen lds
    s_add_u32 s54, s54, 128
    s_cmp_eq_u32 s54, 896
    s_cselect_b32 s54, 0, s54
    v_lshl_add_u32 v6, v6, 1, v9
    s_lshl_b32 s60, s66, 4
    v_mfma_f32_32x32x16_bf16 v[164:179], v[192:195], v[40:43], v[164:179]
    ds_read_b64_tr_b16 v[184:185], v244 offset:6144
    ds_read_b64_tr_b16 v[186:187], v244 offset:6656
    buffer_load_dwordx4 v233, s[28:31], s93 offen offset:1024 lds
    v_add_u32 v6, s60, v6
    v_add_u32 v7, 0, v6
    s_waitcnt lgkmcnt(4)
    v_mfma_f32_32x32x16_bf16 v[148:163], v[196:199], v[44:47], v[148:163]
    ds_read_b64_tr_b16 v[188:189], v243 offset:8192
    ds_read_b64_tr_b16 v[190:191], v243 offset:8704
    buffer_load_dwordx4 v234, s[28:31], s93 offen offset:2048 lds
    v_mul_u32_u24 v8, 9363, v7
    v_lshrrev_b32 v8, 16, v8
    v_mfma_f32_32x32x16_bf16 v[164:179], v[200:203], v[44:47], v[164:179]
    ds_read_b64_tr_b16 v[192:193], v244 offset:8192
    ds_read_b64_tr_b16 v[194:195], v244 offset:8704
    buffer_load_dwordx4 v235, s[28:31], s93 offen offset:3072 lds
    v_lshl_add_u32 v246, v8, 18, v5
    v_mul_u32_u24 v8, 7, v8
    s_waitcnt lgkmcnt(4)
    v_mfma_f32_32x32x16_bf16 v[148:163], v[180:183], v[48:51], v[148:163]
    ds_read_b64_tr_b16 v[196:197], v243 offset:10240
    ds_read_b64_tr_b16 v[198:199], v243 offset:10752
    v_sub_u32 v7, v7, v8
    v_lshl_add_u32 v246, v7, 8, v246
    v_mfma_f32_32x32x16_bf16 v[164:179], v[184:187], v[48:51], v[164:179]
    ds_read_b64_tr_b16 v[200:201], v244 offset:10240
    ds_read_b64_tr_b16 v[202:203], v244 offset:10752
    v_add_u32 v7, 4, v6
    v_mul_u32_u24 v8, 9363, v7
    s_waitcnt lgkmcnt(4)
    s_waitcnt vmcnt(4)
    v_mfma_f32_32x32x16_bf16 v[148:163], v[188:191], v[52:55], v[148:163]
    ds_read_b128 v[68:71], v239 offset:0
    ds_read_b128 v[72:75], v240 offset:0
    ds_read_b128 v[76:79], v241 offset:0
    ds_read_b128 v[80:83], v242 offset:0
    v_lshrrev_b32 v8, 16, v8
    v_lshl_add_u32 v247, v8, 18, v5
    v_mfma_f32_32x32x16_bf16 v[164:179], v[192:195], v[52:55], v[164:179]
    ds_read_b64_tr_b16 v[180:181], v243 offset:12288
    ds_read_b64_tr_b16 v[182:183], v243 offset:12800
    ds_read_b64_tr_b16 v[184:185], v244 offset:12288
    ds_read_b64_tr_b16 v[186:187], v244 offset:12800
    v_mul_u32_u24 v8, 7, v8
    v_sub_u32 v7, v7, v8
    s_waitcnt lgkmcnt(4)
    v_mfma_f32_32x32x16_bf16 v[148:163], v[196:199], v[56:59], v[148:163]
    ds_read_b64_tr_b16 v[188:189], v243 offset:14336
    ds_read_b64_tr_b16 v[190:191], v243 offset:14848
    s_add_u32 m0, s69, 0
    s_add_u32 s93, s54, s55
    buffer_load_dwordx4 v232, s[28:31], s93 offen lds
    s_add_u32 s54, s54, 128
    s_cmp_eq_u32 s54, 896
    s_cselect_b32 s54, 0, s54
    v_lshl_add_u32 v247, v7, 8, v247
    v_add_u32 v7, 8, v6
    v_mfma_f32_32x32x16_bf16 v[164:179], v[200:203], v[56:59], v[164:179]
    ds_read_b64_tr_b16 v[192:193], v244 offset:14336
    ds_read_b64_tr_b16 v[194:195], v244 offset:14848
    buffer_load_dwordx4 v233, s[28:31], s93 offen offset:1024 lds
    v_mul_u32_u24 v8, 9363, v7
    v_lshrrev_b32 v8, 16, v8
    s_waitcnt lgkmcnt(4)
    s_barrier
    v_mfma_f32_32x32x16_bf16 v[148:163], v[180:183], v[60:63], v[148:163]
    ds_read_b64_tr_b16 v[196:197], v243 offset:16384
    ds_read_b64_tr_b16 v[198:199], v243 offset:16896
    buffer_load_dwordx4 v234, s[28:31], s93 offen offset:2048 lds
    v_lshl_add_u32 v248, v8, 18, v5
    v_mul_u32_u24 v8, 7, v8
    v_mfma_f32_32x32x16_bf16 v[164:179], v[184:187], v[60:63], v[164:179]
    ds_read_b64_tr_b16 v[200:201], v244 offset:16384
    ds_read_b64_tr_b16 v[202:203], v244 offset:16896
    buffer_load_dwordx4 v235, s[28:31], s93 offen offset:3072 lds
    v_sub_u32 v7, v7, v8
    v_lshl_add_u32 v248, v7, 8, v248
    s_waitcnt lgkmcnt(4)
    v_mfma_f32_32x32x16_bf16 v[148:163], v[188:191], v[64:67], v[148:163]
    ds_read_b64_tr_b16 v[180:181], v243 offset:18432
    ds_read_b64_tr_b16 v[182:183], v243 offset:18944
    v_add_u32 v7, 12, v6
    v_mul_u32_u24 v8, 9363, v7
    v_mfma_f32_32x32x16_bf16 v[164:179], v[192:195], v[64:67], v[164:179]
    ds_read_b64_tr_b16 v[184:185], v244 offset:18432
    ds_read_b64_tr_b16 v[186:187], v244 offset:18944
    v_lshrrev_b32 v8, 16, v8
    v_lshl_add_u32 v249, v8, 18, v5
    s_waitcnt lgkmcnt(4)
    s_waitcnt vmcnt(4)
    v_mfma_f32_32x32x16_bf16 v[148:163], v[196:199], v[68:71], v[148:163]
    ds_read_b128 v[84:87], v239 offset:16384
    ds_read_b128 v[88:91], v240 offset:16384
    ds_read_b128 v[92:95], v241 offset:16384
    ds_read_b128 v[96:99], v242 offset:16384
    v_mul_u32_u24 v8, 7, v8
    v_sub_u32 v7, v7, v8
    v_mfma_f32_32x32x16_bf16 v[164:179], v[200:203], v[68:71], v[164:179]
    ds_read_b64_tr_b16 v[188:189], v243 offset:20480
    ds_read_b64_tr_b16 v[190:191], v243 offset:20992
    ds_read_b64_tr_b16 v[192:193], v244 offset:20480
    ds_read_b64_tr_b16 v[194:195], v244 offset:20992
    v_lshl_add_u32 v249, v7, 8, v249
    s_mul_i32 s62, s66, 149808
    s_waitcnt lgkmcnt(4)
    v_mfma_f32_32x32x16_bf16 v[148:163], v[180:183], v[72:75], v[148:163]
    ds_read_b64_tr_b16 v[196:197], v243 offset:22528
    ds_read_b64_tr_b16 v[198:199], v243 offset:23040
    s_add_u32 m0, s69, 16384
    s_add_u32 s93, s54, s55
    buffer_load_dwordx4 v232, s[28:31], s93 offen lds
    s_add_u32 s54, s54, 128
    s_cmp_eq_u32 s54, 896
    s_cselect_b32 s54, 0, s54
    s_add_u32 s63, s62, 149808
    s_lshr_b32 s62, s62, 16
    v_mfma_f32_32x32x16_bf16 v[164:179], v[184:187], v[72:75], v[164:179]
    ds_read_b64_tr_b16 v[200:201], v244 offset:22528
    ds_read_b64_tr_b16 v[202:203], v244 offset:23040
    buffer_load_dwordx4 v233, s[28:31], s93 offen offset:1024 lds
    s_lshr_b32 s63, s63, 16
    s_sub_u32 s63, s63, s62
    s_waitcnt lgkmcnt(4)
    v_mfma_f32_32x32x16_bf16 v[148:163], v[188:191], v[76:79], v[148:163]
    ds_read_b64_tr_b16 v[180:181], v243 offset:24576
    ds_read_b64_tr_b16 v[182:183], v243 offset:25088
    buffer_load_dwordx4 v234, s[28:31], s93 offen offset:2048 lds
    s_lshl_b32 s62, s62, 18
    s_add_u32 s62, s62, 1792
    v_mfma_f32_32x32x16_bf16 v[164:179], v[192:195], v[76:79], v[164:179]
    ds_read_b64_tr_b16 v[184:185], v244 offset:24576
    ds_read_b64_tr_b16 v[186:187], v244 offset:25088
    buffer_load_dwordx4 v235, s[28:31], s93 offen offset:3072 lds
    v_lshrrev_b32 v6, 4, v1
    v_cmp_gt_u32 vcc, s63, v6
    s_waitcnt lgkmcnt(4)
    v_mfma_f32_32x32x16_bf16 v[148:163], v[196:199], v[80:83], v[148:163]
    ds_read_b64_tr_b16 v[188:189], v243 offset:26624
    ds_read_b64_tr_b16 v[190:191], v243 offset:27136
    v_lshl_add_u32 v5, v6, 18, v5
    v_add_u32 v5, s62, v5
    v_mfma_f32_32x32x16_bf16 v[164:179], v[200:203], v[80:83], v[164:179]
    ds_read_b64_tr_b16 v[192:193], v244 offset:26624
    ds_read_b64_tr_b16 v[194:195], v244 offset:27136
    v_mov_b32 v8, 1073741824
    v_cndmask_b32 v250, v8, v5, vcc
    s_waitcnt lgkmcnt(4)
    s_waitcnt vmcnt(4)
    v_mfma_f32_32x32x16_bf16 v[148:163], v[180:183], v[84:87], v[148:163]
    ds_read_b128 v[100:103], v239 offset:0
    ds_read_b128 v[104:107], v240 offset:0
    ds_read_b128 v[108:111], v241 offset:0
    ds_read_b128 v[112:115], v242 offset:0
    v_mfma_f32_32x32x16_bf16 v[164:179], v[184:187], v[84:87], v[164:179]
    ds_read_b64_tr_b16 v[196:197], v243 offset:28672
    ds_read_b64_tr_b16 v[198:199], v243 offset:29184
    ds_read_b64_tr_b16 v[200:201], v244 offset:28672
    ds_read_b64_tr_b16 v[202:203], v244 offset:29184
    s_waitcnt lgkmcnt(4)
    v_mfma_f32_32x32x16_bf16 v[148:163], v[188:191], v[88:91], v[148:163]
    ds_read_b64_tr_b16 v[180:181], v243 offset:30720
    ds_read_b64_tr_b16 v[182:183], v243 offset:31232
    s_add_u32 m0, s69, 0
    s_add_u32 s93, s54, s55
    buffer_load_dwordx4 v232, s[28:31], s93 offen lds
    s_add_u32 s54, s54, 128
    s_cmp_eq_u32 s54, 896
    s_cselect_b32 s54, 0, s54
    v_mfma_f32_32x32x16_bf16 v[164:179], v[192:195], v[88:91], v[164:179]
    ds_read_b64_tr_b16 v[184:185], v244 offset:30720
    ds_read_b64_tr_b16 v[186:187], v244 offset:31232
    buffer_load_dwordx4 v233, s[28:31], s93 offen offset:1024 lds
    s_waitcnt lgkmcnt(4)
    v_mfma_f32_32x32x16_bf16 v[148:163], v[196:199], v[92:95], v[148:163]
    ds_read_b64_tr_b16 v[188:189], v243 offset:32768
    ds_read_b64_tr_b16 v[190:191], v243 offset:33280
    buffer_load_dwordx4 v234, s[28:31], s93 offen offset:2048 lds
    v_mfma_f32_32x32x16_bf16 v[164:179], v[200:203], v[92:95], v[164:179]
    ds_read_b64_tr_b16 v[192:193], v244 offset:32768
    ds_read_b64_tr_b16 v[194:195], v244 offset:33280
    buffer_load_dwordx4 v235, s[28:31], s93 offen offset:3072 lds
    buffer_store_dwordx4 v[252:255], v250, s[36:39], s92 offen offset:0 sc1
    s_waitcnt lgkmcnt(4)
    v_mfma_f32_32x32x16_bf16 v[148:163], v[180:183], v[96:99], v[148:163]
    ds_read_b64_tr_b16 v[196:197], v243 offset:34816
    ds_read_b64_tr_b16 v[198:199], v243 offset:35328
    v_mfma_f32_32x32x16_bf16 v[164:179], v[184:187], v[96:99], v[164:179]
    ds_read_b64_tr_b16 v[200:201], v244 offset:34816
    ds_read_b64_tr_b16 v[202:203], v244 offset:35328
    s_waitcnt lgkmcnt(4)
    s_waitcnt vmcnt(5)
    v_mfma_f32_32x32x16_bf16 v[148:163], v[188:191], v[100:103], v[148:163]
    ds_read_b128 v[116:119], v239 offset:16384
    ds_read_b128 v[120:123], v240 offset:16384
    ds_read_b128 v[124:127], v241 offset:16384
    ds_read_b128 v[128:131], v242 offset:16384
    v_mfma_f32_32x32x16_bf16 v[164:179], v[192:195], v[100:103], v[164:179]
    ds_read_b64_tr_b16 v[180:181], v243 offset:36864
    ds_read_b64_tr_b16 v[182:183], v243 offset:37376
    ds_read_b64_tr_b16 v[184:185], v244 offset:36864
    ds_read_b64_tr_b16 v[186:187], v244 offset:37376
    s_waitcnt lgkmcnt(8)
    v_mfma_f32_32x32x16_bf16 v[148:163], v[196:199], v[104:107], v[148:163]
    ds_read_b64_tr_b16 v[188:189], v243 offset:38912
    ds_read_b64_tr_b16 v[190:191], v243 offset:39424
    v_mfma_f32_32x32x16_bf16 v[164:179], v[200:203], v[104:107], v[164:179]
    ds_read_b64_tr_b16 v[192:193], v244 offset:38912
    ds_read_b64_tr_b16 v[194:195], v244 offset:39424
    s_waitcnt lgkmcnt(4)
    v_mfma_f32_32x32x16_bf16 v[148:163], v[180:183], v[108:111], v[148:163]
    ds_read_b64_tr_b16 v[196:197], v243 offset:40960
    ds_read_b64_tr_b16 v[198:199], v243 offset:41472
    v_mfma_f32_32x32x16_bf16 v[164:179], v[184:187], v[108:111], v[164:179]
    ds_read_b64_tr_b16 v[200:201], v244 offset:40960
    ds_read_b64_tr_b16 v[202:203], v244 offset:41472
    s_waitcnt lgkmcnt(4)
    v_mfma_f32_32x32x16_bf16 v[148:163], v[188:191], v[112:115], v[148:163]
    ds_read_b64_tr_b16 v[180:181], v243 offset:43008
    ds_read_b64_tr_b16 v[182:183], v243 offset:43520
    v_mfma_f32_32x32x16_bf16 v[164:179], v[192:195], v[112:115], v[164:179]
    ds_read_b64_tr_b16 v[184:185], v244 offset:43008
    ds_read_b64_tr_b16 v[186:187], v244 offset:43520
    s_waitcnt lgkmcnt(4)
    s_waitcnt vmcnt(1)
    v_mfma_f32_32x32x16_bf16 v[148:163], v[196:199], v[116:119], v[148:163]
    ds_read_b128 v[132:135], v239 offset:0
    ds_read_b128 v[136:139], v240 offset:0
    ds_read_b128 v[140:143], v241 offset:0
    ds_read_b128 v[144:147], v242 offset:0
    v_mfma_f32_32x32x16_bf16 v[164:179], v[200:203], v[116:119], v[164:179]
    ds_read_b64_tr_b16 v[188:189], v243 offset:45056
    ds_read_b64_tr_b16 v[190:191], v243 offset:45568
    ds_read_b64_tr_b16 v[192:193], v244 offset:45056
    ds_read_b64_tr_b16 v[194:195], v244 offset:45568
    s_waitcnt lgkmcnt(8)
    v_mfma_f32_32x32x16_bf16 v[148:163], v[180:183], v[120:123], v[148:163]
    ds_read_b64_tr_b16 v[196:197], v243 offset:47104
    ds_read_b64_tr_b16 v[198:199], v243 offset:47616
    v_mfma_f32_32x32x16_bf16 v[164:179], v[184:187], v[120:123], v[164:179]
    ds_read_b64_tr_b16 v[200:201], v244 offset:47104
    ds_read_b64_tr_b16 v[202:203], v244 offset:47616
    s_waitcnt lgkmcnt(4)
    v_mfma_f32_32x32x16_bf16 v[148:163], v[188:191], v[124:127], v[148:163]
    ds_read_b64_tr_b16 v[180:181], v243 offset:49152
    ds_read_b64_tr_b16 v[182:183], v243 offset:49664
    v_mfma_f32_32x32x16_bf16 v[164:179], v[192:195], v[124:127], v[164:179]
    ds_read_b64_tr_b16 v[184:185], v244 offset:49152
    ds_read_b64_tr_b16 v[186:187], v244 offset:49664
    s_waitcnt lgkmcnt(4)
    s_barrier
    v_mfma_f32_32x32x16_bf16 v[148:163], v[196:199], v[128:131], v[148:163]
    ds_read_b64_tr_b16 v[188:189], v243 offset:51200
    ds_read_b64_tr_b16 v[190:191], v243 offset:51712
    v_mfma_f32_32x32x16_bf16 v[164:179], v[200:203], v[128:131], v[164:179]
    ds_read_b64_tr_b16 v[192:193], v244 offset:51200
    ds_read_b64_tr_b16 v[194:195], v244 offset:51712
    s_waitcnt lgkmcnt(4)
    v_mfma_f32_32x32x16_bf16 v[148:163], v[180:183], v[132:135], v[148:163]
    ds_read_b64_tr_b16 v[196:197], v243 offset:53248
    ds_read_b64_tr_b16 v[198:199], v243 offset:53760
    v_mfma_f32_32x32x16_bf16 v[164:179], v[184:187], v[132:135], v[164:179]
    ds_read_b64_tr_b16 v[200:201], v244 offset:53248
    ds_read_b64_tr_b16 v[202:203], v244 offset:53760
    s_waitcnt lgkmcnt(4)
    v_mfma_f32_32x32x16_bf16 v[148:163], v[188:191], v[136:139], v[148:163]
    ds_read_b64_tr_b16 v[180:181], v243 offset:55296
    ds_read_b64_tr_b16 v[182:183], v243 offset:55808
    v_mfma_f32_32x32x16_bf16 v[164:179], v[192:195], v[136:139], v[164:179]
    ds_read_b64_tr_b16 v[184:185], v244 offset:55296
    ds_read_b64_tr_b16 v[186:187], v244 offset:55808
    s_waitcnt lgkmcnt(4)
    v_mfma_f32_32x32x16_bf16 v[148:163], v[196:199], v[140:143], v[148:163]
    v_mfma_f32_32x32x16_bf16 v[164:179], v[200:203], v[140:143], v[164:179]
    s_waitcnt lgkmcnt(0)
    v_mfma_f32_32x32x16_bf16 v[148:163], v[180:183], v[144:147], v[148:163]
    v_mfma_f32_32x32x16_bf16 v[164:179], v[184:187], v[144:147], v[164:179]
    s_nop 0
    s_nop 6
    s_nop 2
    v_cvt_pk_bf16_f32 v180, v148, v149
    v_cvt_pk_bf16_f32 v181, v150, v151
    v_cvt_pk_bf16_f32 v182, v152, v153
    v_cvt_pk_bf16_f32 v183, v154, v155
    v_cvt_pk_bf16_f32 v184, v156, v157
    v_cvt_pk_bf16_f32 v185, v158, v159
    v_cvt_pk_bf16_f32 v186, v160, v161
    v_cvt_pk_bf16_f32 v187, v162, v163
    v_permlane16_swap_b32 v180, v182
    v_permlane16_swap_b32 v181, v183
    buffer_store_dwordx4 v[180:183], v246, s[36:39], s92 offen offset:0 sc1
    v_permlane16_swap_b32 v184, v186
    v_permlane16_swap_b32 v185, v187
    buffer_store_dwordx4 v[184:187], v247, s[36:39], s92 offen offset:0 sc1
    v_cvt_pk_bf16_f32 v188, v164, v165
    v_cvt_pk_bf16_f32 v189, v166, v167
    v_cvt_pk_bf16_f32 v190, v168, v169
    v_cvt_pk_bf16_f32 v191, v170, v171
    v_cvt_pk_bf16_f32 v192, v172, v173
    v_cvt_pk_bf16_f32 v193, v174, v175
    v_cvt_pk_bf16_f32 v194, v176, v177
    v_cvt_pk_bf16_f32 v195, v178, v179
    v_permlane16_swap_b32 v188, v190
    v_permlane16_swap_b32 v189, v191
    buffer_store_dwordx4 v[188:191], v248, s[36:39], s92 offen offset:0 sc1
    v_permlane16_swap_b32 v192, v194
    v_permlane16_swap_b32 v193, v195
    buffer_store_dwordx4 v[192:195], v249, s[36:39], s92 offen offset:0 sc1
    s_branch L_oq
L_oV:
    s_waitcnt vmcnt(4)
    ds_read_b128 v[36:39], v239 offset:0
    ds_read_b128 v[40:43], v240 offset:0
    ds_read_b128 v[44:47], v241 offset:0
    ds_read_b128 v[48:51], v242 offset:0
    s_waitcnt lgkmcnt(0)
    s_add_u32 m0, s69, 0
    s_add_u32 s93, s54, s55
    buffer_load_dwordx4 v232, s[28:31], s93 offen lds
    s_add_u32 s54, s54, 128
    s_cmp_eq_u32 s54, 896
    s_cselect_b32 s54, 0, s54
    buffer_load_dwordx4 v233, s[28:31], s93 offen offset:1024 lds
    buffer_load_dwordx4 v234, s[28:31], s93 offen offset:2048 lds
    buffer_load_dwordx4 v235, s[28:31], s93 offen offset:3072 lds
    s_barrier
    ds_read_b64_tr_b16 v[180:181], v243 offset:0
    ds_read_b64_tr_b16 v[182:183], v243 offset:512
    ds_read_b64_tr_b16 v[184:185], v244 offset:0
    ds_read_b64_tr_b16 v[186:187], v244 offset:512
    ds_read_b64_tr_b16 v[188:189], v243 offset:2048
    ds_read_b64_tr_b16 v[190:191], v243 offset:2560
    ds_read_b64_tr_b16 v[192:193], v244 offset:2048
    ds_read_b64_tr_b16 v[194:195], v244 offset:2560
    s_waitcnt lgkmcnt(4)
    s_waitcnt vmcnt(4)
    v_mfma_f32_32x32x16_bf16 v[148:163], v[36:39], v[180:183], 0
    ds_read_b128 v[52:55], v239 offset:16384
    ds_read_b128 v[56:59], v240 offset:16384
    ds_read_b128 v[60:63], v241 offset:16384
    ds_read_b128 v[64:67], v242 offset:16384
    v_and_b32 v5, 31, v1
    s_lshl_b32 s60, s66, 6
    v_mfma_f32_32x32x16_bf16 v[164:179], v[36:39], v[184:187], 0
    ds_read_b64_tr_b16 v[196:197], v243 offset:4096
    ds_read_b64_tr_b16 v[198:199], v243 offset:4608
    ds_read_b64_tr_b16 v[200:201], v244 offset:4096
    ds_read_b64_tr_b16 v[202:203], v244 offset:4608
    v_add_u32 v5, s60, v5
    v_and_b32 v9, 32, v1
    s_waitcnt lgkmcnt(4)
    v_mfma_f32_32x32x16_bf16 v[148:163], v[40:43], v[188:191], v[148:163]
    ds_read_b64_tr_b16 v[180:181], v243 offset:6144
    ds_read_b64_tr_b16 v[182:183], v243 offset:6656
    s_add_u32 m0, s69, 16384
    s_add_u32 s93, s54, s55
    buffer_load_dwordx4 v232, s[28:31], s93 offen lds
    s_add_u32 s54, s54, 128
    s_cmp_eq_u32 s54, 896
    s_cselect_b32 s54, 0, s54
    v_add_u32 v7, 0, v5
    v_mul_u32_u24 v8, 2341, v7
    v_mfma_f32_32x32x16_bf16 v[164:179], v[40:43], v[192:195], v[164:179]
    ds_read_b64_tr_b16 v[184:185], v244 offset:6144
    ds_read_b64_tr_b16 v[186:187], v244 offset:6656
    buffer_load_dwordx4 v233, s[28:31], s93 offen offset:1024 lds
    v_lshrrev_b32 v8, 16, v8
    v_mul_u32_u24 v6, 28, v8
    s_waitcnt lgkmcnt(4)
    v_mfma_f32_32x32x16_bf16 v[148:163], v[44:47], v[196:199], v[148:163]
    ds_read_b64_tr_b16 v[188:189], v243 offset:8192
    ds_read_b64_tr_b16 v[190:191], v243 offset:8704
    buffer_load_dwordx4 v234, s[28:31], s93 offen offset:2048 lds
    v_sub_u32 v7, v7, v6
    v_add_u32 v7, v7, v9
    v_mfma_f32_32x32x16_bf16 v[164:179], v[44:47], v[200:203], v[164:179]
    ds_read_b64_tr_b16 v[192:193], v244 offset:8192
    ds_read_b64_tr_b16 v[194:195], v244 offset:8704
    buffer_load_dwordx4 v235, s[28:31], s93 offen offset:3072 lds
    v_lshlrev_b32 v7, 4, v7
    v_lshl_add_u32 v7, v8, 18, v7
    s_waitcnt lgkmcnt(4)
    v_mfma_f32_32x32x16_bf16 v[148:163], v[48:51], v[180:183], v[148:163]
    ds_read_b64_tr_b16 v[196:197], v243 offset:10240
    ds_read_b64_tr_b16 v[198:199], v243 offset:10752
    v_add_u32 v246, 2048, v7
    v_add_u32 v247, 3072, v7
    v_mfma_f32_32x32x16_bf16 v[164:179], v[48:51], v[184:187], v[164:179]
    ds_read_b64_tr_b16 v[200:201], v244 offset:10240
    ds_read_b64_tr_b16 v[202:203], v244 offset:10752
    v_add_u32 v7, 32, v5
    v_mul_u32_u24 v8, 2341, v7
    s_waitcnt lgkmcnt(4)
    s_waitcnt vmcnt(4)
    v_mfma_f32_32x32x16_bf16 v[148:163], v[52:55], v[188:191], v[148:163]
    ds_read_b128 v[68:71], v239 offset:0
    ds_read_b128 v[72:75], v240 offset:0
    ds_read_b128 v[76:79], v241 offset:0
    ds_read_b128 v[80:83], v242 offset:0
    v_lshrrev_b32 v8, 16, v8
    v_mul_u32_u24 v6, 28, v8
    v_mfma_f32_32x32x16_bf16 v[164:179], v[52:55], v[192:195], v[164:179]
    ds_read_b64_tr_b16 v[180:181], v243 offset:12288
    ds_read_b64_tr_b16 v[182:183], v243 offset:12800
    ds_read_b64_tr_b16 v[184:185], v244 offset:12288
    ds_read_b64_tr_b16 v[186:187], v244 offset:12800
    v_sub_u32 v7, v7, v6
    v_add_u32 v7, v7, v9
    s_waitcnt lgkmcnt(4)
    v_mfma_f32_32x32x16_bf16 v[148:163], v[56:59], v[196:199], v[148:163]
    ds_read_b64_tr_b16 v[188:189], v243 offset:14336
    ds_read_b64_tr_b16 v[190:191], v243 offset:14848
    s_add_u32 m0, s69, 0
    s_add_u32 s93, s54, s55
    buffer_load_dwordx4 v232, s[28:31], s93 offen lds
    s_add_u32 s54, s54, 128
    s_cmp_eq_u32 s54, 896
    s_cselect_b32 s54, 0, s54
    v_lshlrev_b32 v7, 4, v7
    v_lshl_add_u32 v7, v8, 18, v7
    v_mfma_f32_32x32x16_bf16 v[164:179], v[56:59], v[200:203], v[164:179]
    ds_read_b64_tr_b16 v[192:193], v244 offset:14336
    ds_read_b64_tr_b16 v[194:195], v244 offset:14848
    buffer_load_dwordx4 v233, s[28:31], s93 offen offset:1024 lds
    v_add_u32 v248, 2048, v7
    v_add_u32 v249, 3072, v7
    s_waitcnt lgkmcnt(4)
    s_barrier
    v_mfma_f32_32x32x16_bf16 v[148:163], v[60:63], v[180:183], v[148:163]
    ds_read_b64_tr_b16 v[196:197], v243 offset:16384
    ds_read_b64_tr_b16 v[198:199], v243 offset:16896
    buffer_load_dwordx4 v234, s[28:31], s93 offen offset:2048 lds
    s_mul_i32 s62, s66, 149808
    s_add_u32 s63, s62, 149808
    v_mfma_f32_32x32x16_bf16 v[164:179], v[60:63], v[184:187], v[164:179]
    ds_read_b64_tr_b16 v[200:201], v244 offset:16384
    ds_read_b64_tr_b16 v[202:203], v244 offset:16896
    buffer_load_dwordx4 v235, s[28:31], s93 offen offset:3072 lds
    s_lshr_b32 s62, s62, 16
    s_lshr_b32 s63, s63, 16
    s_waitcnt lgkmcnt(4)
    v_mfma_f32_32x32x16_bf16 v[148:163], v[64:67], v[188:191], v[148:163]
    ds_read_b64_tr_b16 v[180:181], v243 offset:18432
    ds_read_b64_tr_b16 v[182:183], v243 offset:18944
    s_sub_u32 s63, s63, s62
    s_lshl_b32 s62, s62, 18
    v_mfma_f32_32x32x16_bf16 v[164:179], v[64:67], v[192:195], v[164:179]
    ds_read_b64_tr_b16 v[184:185], v244 offset:18432
    ds_read_b64_tr_b16 v[186:187], v244 offset:18944
    s_add_u32 s62, s62, 2496
    v_lshrrev_b32 v5, 4, v1
    s_waitcnt lgkmcnt(4)
    s_waitcnt vmcnt(4)
    v_mfma_f32_32x32x16_bf16 v[148:163], v[68:71], v[196:199], v[148:163]
    ds_read_b128 v[84:87], v239 offset:16384
    ds_read_b128 v[88:91], v240 offset:16384
    ds_read_b128 v[92:95], v241 offset:16384
    ds_read_b128 v[96:99], v242 offset:16384
    v_cmp_gt_u32 vcc, s63, v5
    v_bfe_u32 v6, v1, 2, 2
    v_mfma_f32_32x32x16_bf16 v[164:179], v[68:71], v[200:203], v[164:179]
    ds_read_b64_tr_b16 v[188:189], v243 offset:20480
    ds_read_b64_tr_b16 v[190:191], v243 offset:20992
    ds_read_b64_tr_b16 v[192:193], v244 offset:20480
    ds_read_b64_tr_b16 v[194:195], v244 offset:20992
    v_lshlrev_b32 v6, 9, v6
    v_lshl_add_u32 v6, v5, 18, v6
    s_waitcnt lgkmcnt(4)
    v_mfma_f32_32x32x16_bf16 v[148:163], v[72:75], v[180:183], v[148:163]
    ds_read_b64_tr_b16 v[196:197], v243 offset:22528
    ds_read_b64_tr_b16 v[198:199], v243 offset:23040
    s_add_u32 m0, s69, 16384
    s_add_u32 s93, s54, s55
    buffer_load_dwordx4 v232, s[28:31], s93 offen lds
    s_add_u32 s54, s54, 128
    s_cmp_eq_u32 s54, 896
    s_cselect_b32 s54, 0, s54
    v_and_b32 v7, 3, v1
    v_lshl_add_u32 v6, v7, 4, v6
    v_mfma_f32_32x32x16_bf16 v[164:179], v[72:75], v[184:187], v[164:179]
    ds_read_b64_tr_b16 v[200:201], v244 offset:22528
    ds_read_b64_tr_b16 v[202:203], v244 offset:23040
    buffer_load_dwordx4 v233, s[28:31], s93 offen offset:1024 lds
    v_add_u32 v6, s62, v6
    v_mov_b32 v8, 1073741824
    s_waitcnt lgkmcnt(4)
    v_mfma_f32_32x32x16_bf16 v[148:163], v[76:79], v[188:191], v[148:163]
    ds_read_b64_tr_b16 v[180:181], v243 offset:24576
    ds_read_b64_tr_b16 v[182:183], v243 offset:25088
    buffer_load_dwordx4 v234, s[28:31], s93 offen offset:2048 lds
    v_cndmask_b32 v250, v8, v6, vcc
    v_cmp_eq_u32 vcc, 0, v7
    v_mfma_f32_32x32x16_bf16 v[164:179], v[76:79], v[192:195], v[164:179]
    ds_read_b64_tr_b16 v[184:185], v244 offset:24576
    ds_read_b64_tr_b16 v[186:187], v244 offset:25088
    buffer_load_dwordx4 v235, s[28:31], s93 offen offset:3072 lds
    v_mov_b32 v8, 0x3f803f80
    s_nop 0
    s_waitcnt lgkmcnt(4)
    v_mfma_f32_32x32x16_bf16 v[148:163], v[80:83], v[196:199], v[148:163]
    ds_read_b64_tr_b16 v[188:189], v243 offset:26624
    ds_read_b64_tr_b16 v[190:191], v243 offset:27136
    v_cndmask_b32 v252, 0, v8, vcc
    v_mov_b32 v253, v252
    v_mfma_f32_32x32x16_bf16 v[164:179], v[80:83], v[200:203], v[164:179]
    ds_read_b64_tr_b16 v[192:193], v244 offset:26624
    ds_read_b64_tr_b16 v[194:195], v244 offset:27136
    v_mov_b32 v254, v252
    v_mov_b32 v255, v252
    s_waitcnt lgkmcnt(4)
    s_waitcnt vmcnt(4)
    v_mfma_f32_32x32x16_bf16 v[148:163], v[84:87], v[180:183], v[148:163]
    ds_read_b128 v[100:103], v239 offset:0
    ds_read_b128 v[104:107], v240 offset:0
    ds_read_b128 v[108:111], v241 offset:0
    ds_read_b128 v[112:115], v242 offset:0
    v_mfma_f32_32x32x16_bf16 v[164:179], v[84:87], v[184:187], v[164:179]
    ds_read_b64_tr_b16 v[196:197], v243 offset:28672
    ds_read_b64_tr_b16 v[198:199], v243 offset:29184
    ds_read_b64_tr_b16 v[200:201], v244 offset:28672
    ds_read_b64_tr_b16 v[202:203], v244 offset:29184
    s_waitcnt lgkmcnt(4)
    v_mfma_f32_32x32x16_bf16 v[148:163], v[88:91], v[188:191], v[148:163]
    ds_read_b64_tr_b16 v[180:181], v243 offset:30720
    ds_read_b64_tr_b16 v[182:183], v243 offset:31232
    s_add_u32 m0, s69, 0
    s_add_u32 s93, s54, s55
    buffer_load_dwordx4 v232, s[28:31], s93 offen lds
    s_add_u32 s54, s54, 128
    s_cmp_eq_u32 s54, 896
    s_cselect_b32 s54, 0, s54
    v_mfma_f32_32x32x16_bf16 v[164:179], v[88:91], v[192:195], v[164:179]
    ds_read_b64_tr_b16 v[184:185], v244 offset:30720
    ds_read_b64_tr_b16 v[186:187], v244 offset:31232
    buffer_load_dwordx4 v233, s[28:31], s93 offen offset:1024 lds
    s_waitcnt lgkmcnt(4)
    v_mfma_f32_32x32x16_bf16 v[148:163], v[92:95], v[196:199], v[148:163]
    ds_read_b64_tr_b16 v[188:189], v243 offset:32768
    ds_read_b64_tr_b16 v[190:191], v243 offset:33280
    buffer_load_dwordx4 v234, s[28:31], s93 offen offset:2048 lds
    v_mfma_f32_32x32x16_bf16 v[164:179], v[92:95], v[200:203], v[164:179]
    ds_read_b64_tr_b16 v[192:193], v244 offset:32768
    ds_read_b64_tr_b16 v[194:195], v244 offset:33280
    buffer_load_dwordx4 v235, s[28:31], s93 offen offset:3072 lds
    buffer_store_dwordx4 v[252:255], v250, s[36:39], s92 offen offset:0 sc1
    s_waitcnt lgkmcnt(4)
    v_mfma_f32_32x32x16_bf16 v[148:163], v[96:99], v[180:183], v[148:163]
    ds_read_b64_tr_b16 v[196:197], v243 offset:34816
    ds_read_b64_tr_b16 v[198:199], v243 offset:35328
    v_mfma_f32_32x32x16_bf16 v[164:179], v[96:99], v[184:187], v[164:179]
    ds_read_b64_tr_b16 v[200:201], v244 offset:34816
    ds_read_b64_tr_b16 v[202:203], v244 offset:35328
    s_waitcnt lgkmcnt(4)
    s_waitcnt vmcnt(5)
    v_mfma_f32_32x32x16_bf16 v[148:163], v[100:103], v[188:191], v[148:163]
    ds_read_b128 v[116:119], v239 offset:16384
    ds_read_b128 v[120:123], v240 offset:16384
    ds_read_b128 v[124:127], v241 offset:16384
    ds_read_b128 v[128:131], v242 offset:16384
    v_mfma_f32_32x32x16_bf16 v[164:179], v[100:103], v[192:195], v[164:179]
    ds_read_b64_tr_b16 v[180:181], v243 offset:36864
    ds_read_b64_tr_b16 v[182:183], v243 offset:37376
    ds_read_b64_tr_b16 v[184:185], v244 offset:36864
    ds_read_b64_tr_b16 v[186:187], v244 offset:37376
    s_waitcnt lgkmcnt(8)
    v_mfma_f32_32x32x16_bf16 v[148:163], v[104:107], v[196:199], v[148:163]
    ds_read_b64_tr_b16 v[188:189], v243 offset:38912
    ds_read_b64_tr_b16 v[190:191], v243 offset:39424
    v_mfma_f32_32x32x16_bf16 v[164:179], v[104:107], v[200:203], v[164:179]
    ds_read_b64_tr_b16 v[192:193], v244 offset:38912
    ds_read_b64_tr_b16 v[194:195], v244 offset:39424
    s_waitcnt lgkmcnt(4)
    v_mfma_f32_32x32x16_bf16 v[148:163], v[108:111], v[180:183], v[148:163]
    ds_read_b64_tr_b16 v[196:197], v243 offset:40960
    ds_read_b64_tr_b16 v[198:199], v243 offset:41472
    v_mfma_f32_32x32x16_bf16 v[164:179], v[108:111], v[184:187], v[164:179]
    ds_read_b64_tr_b16 v[200:201], v244 offset:40960
    ds_read_b64_tr_b16 v[202:203], v244 offset:41472
    s_waitcnt lgkmcnt(4)
    v_mfma_f32_32x32x16_bf16 v[148:163], v[112:115], v[188:191], v[148:163]
    ds_read_b64_tr_b16 v[180:181], v243 offset:43008
    ds_read_b64_tr_b16 v[182:183], v243 offset:43520
    v_mfma_f32_32x32x16_bf16 v[164:179], v[112:115], v[192:195], v[164:179]
    ds_read_b64_tr_b16 v[184:185], v244 offset:43008
    ds_read_b64_tr_b16 v[186:187], v244 offset:43520
    s_waitcnt lgkmcnt(4)
    s_waitcnt vmcnt(1)
    v_mfma_f32_32x32x16_bf16 v[148:163], v[116:119], v[196:199], v[148:163]
    ds_read_b128 v[132:135], v239 offset:0
    ds_read_b128 v[136:139], v240 offset:0
    ds_read_b128 v[140:143], v241 offset:0
    ds_read_b128 v[144:147], v242 offset:0
    v_mfma_f32_32x32x16_bf16 v[164:179], v[116:119], v[200:203], v[164:179]
    ds_read_b64_tr_b16 v[188:189], v243 offset:45056
    ds_read_b64_tr_b16 v[190:191], v243 offset:45568
    ds_read_b64_tr_b16 v[192:193], v244 offset:45056
    ds_read_b64_tr_b16 v[194:195], v244 offset:45568
    s_waitcnt lgkmcnt(8)
    v_mfma_f32_32x32x16_bf16 v[148:163], v[120:123], v[180:183], v[148:163]
    ds_read_b64_tr_b16 v[196:197], v243 offset:47104
    ds_read_b64_tr_b16 v[198:199], v243 offset:47616
    v_mfma_f32_32x32x16_bf16 v[164:179], v[120:123], v[184:187], v[164:179]
    ds_read_b64_tr_b16 v[200:201], v244 offset:47104
    ds_read_b64_tr_b16 v[202:203], v244 offset:47616
    s_waitcnt lgkmcnt(4)
    v_mfma_f32_32x32x16_bf16 v[148:163], v[124:127], v[188:191], v[148:163]
    ds_read_b64_tr_b16 v[180:181], v243 offset:49152
    ds_read_b64_tr_b16 v[182:183], v243 offset:49664
    v_mfma_f32_32x32x16_bf16 v[164:179], v[124:127], v[192:195], v[164:179]
    ds_read_b64_tr_b16 v[184:185], v244 offset:49152
    ds_read_b64_tr_b16 v[186:187], v244 offset:49664
    s_waitcnt lgkmcnt(4)
    s_barrier
    v_mfma_f32_32x32x16_bf16 v[148:163], v[128:131], v[196:199], v[148:163]
    ds_read_b64_tr_b16 v[188:189], v243 offset:51200
    ds_read_b64_tr_b16 v[190:191], v243 offset:51712
    v_mfma_f32_32x32x16_bf16 v[164:179], v[128:131], v[200:203], v[164:179]
    ds_read_b64_tr_b16 v[192:193], v244 offset:51200
    ds_read_b64_tr_b16 v[194:195], v244 offset:51712
    s_waitcnt lgkmcnt(4)
    v_mfma_f32_32x32x16_bf16 v[148:163], v[132:135], v[180:183], v[148:163]
    ds_read_b64_tr_b16 v[196:197], v243 offset:53248
    ds_read_b64_tr_b16 v[198:199], v243 offset:53760
    v_mfma_f32_32x32x16_bf16 v[164:179], v[132:135], v[184:187], v[164:179]
    ds_read_b64_tr_b16 v[200:201], v244 offset:53248
    ds_read_b64_tr_b16 v[202:203], v244 offset:53760
    s_waitcnt lgkmcnt(4)
    v_mfma_f32_32x32x16_bf16 v[148:163], v[136:139], v[188:191], v[148:163]
    ds_read_b64_tr_b16 v[180:181], v243 offset:55296
    ds_read_b64_tr_b16 v[182:183], v243 offset:55808
    v_mfma_f32_32x32x16_bf16 v[164:179], v[136:139], v[192:195], v[164:179]
    ds_read_b64_tr_b16 v[184:185], v244 offset:55296
    ds_read_b64_tr_b16 v[186:187], v244 offset:55808
    s_waitcnt lgkmcnt(4)
    v_mfma_f32_32x32x16_bf16 v[148:163], v[140:143], v[196:199], v[148:163]
    v_mfma_f32_32x32x16_bf16 v[164:179], v[140:143], v[200:203], v[164:179]
    s_waitcnt lgkmcnt(0)
    v_mfma_f32_32x32x16_bf16 v[148:163], v[144:147], v[180:183], v[148:163]
    v_mfma_f32_32x32x16_bf16 v[164:179], v[144:147], v[184:187], v[164:179]
    s_nop 0
    s_nop 6
    s_nop 2
    v_cvt_pk_bf16_f32 v180, v148, v149
    v_cvt_pk_bf16_f32 v181, v150, v151
    v_cvt_pk_bf16_f32 v182, v152, v153
    v_cvt_pk_bf16_f32 v183, v154, v155
    buffer_store_dwordx4 v[180:183], v246, s[36:39], s92 offen offset:0 sc1
    v_cvt_pk_bf16_f32 v184, v156, v157
    v_cvt_pk_bf16_f32 v185, v158, v159
    v_cvt_pk_bf16_f32 v186, v160, v161
    v_cvt_pk_bf16_f32 v187, v162, v163
    buffer_store_dwordx4 v[184:187], v247, s[36:39], s92 offen offset:0 sc1
    v_cvt_pk_bf16_f32 v188, v164, v165
    v_cvt_pk_bf16_f32 v189, v166, v167
    v_cvt_pk_bf16_f32 v190, v168, v169
    v_cvt_pk_bf16_f32 v191, v170, v171
    buffer_store_dwordx4 v[188:191], v248, s[36:39], s92 offen offset:0 sc1
    v_cvt_pk_bf16_f32 v192, v172, v173
    v_cvt_pk_bf16_f32 v193, v174, v175
    v_cvt_pk_bf16_f32 v194, v176, v177
    v_cvt_pk_bf16_f32 v195, v178, v179
    buffer_store_dwordx4 v[192:195], v249, s[36:39], s92 offen offset:0 sc1
    s_branch L_oq
L_oN:
    s_mov_b64 exec, 1
    buffer_store_dword v31, v3, s[36:39], s79 offen offset:0 sc1
    s_mov_b64 exec, -1
    s_waitcnt vmcnt(5)
    ds_read_b128 v[36:39], v239 offset:0
    ds_read_b128 v[40:43], v240 offset:0
    ds_read_b128 v[44:47], v241 offset:0
    ds_read_b128 v[48:51], v242 offset:0
    s_waitcnt lgkmcnt(0)
    s_add_u32 m0, s69, 0
    s_add_u32 s93, s54, s55
    buffer_load_dwordx4 v232, s[28:31], s93 offen lds
    s_add_u32 s54, s54, 128
    s_cmp_eq_u32 s54, 896
    s_cselect_b32 s54, 0, s54
    buffer_load_dwordx4 v233, s[28:31], s93 offen offset:1024 lds
    buffer_load_dwordx4 v234, s[28:31], s93 offen offset:2048 lds
    buffer_load_dwordx4 v235, s[28:31], s93 offen offset:3072 lds
    s_waitcnt vmcnt(5)
    ds_read_b128 v[52:55], v239 offset:16384
    ds_read_b128 v[56:59], v240 offset:16384
    ds_read_b128 v[60:63], v241 offset:16384
    ds_read_b128 v[64:67], v242 offset:16384
    s_waitcnt lgkmcnt(0)
    s_add_u32 m0, s69, 16384
    s_add_u32 s93, s54, s55
    buffer_load_dwordx4 v232, s[28:31], s93 offen lds
    s_add_u32 s54, s54, 128
    s_cmp_eq_u32 s54, 896
    s_cselect_b32 s54, 0, s54
    buffer_load_dwordx4 v233, s[28:31], s93 offen offset:1024 lds
    buffer_load_dwordx4 v234, s[28:31], s93 offen offset:2048 lds
    buffer_load_dwordx4 v235, s[28:31], s93 offen offset:3072 lds
    s_waitcnt vmcnt(4)
    ds_read_b128 v[68:71], v239 offset:0
    ds_read_b128 v[72:75], v240 offset:0
    ds_read_b128 v[76:79], v241 offset:0
    ds_read_b128 v[80:83], v242 offset:0
    s_waitcnt lgkmcnt(0)
    s_add_u32 m0, s69, 0
    s_add_u32 s93, s54, s55
    buffer_load_dwordx4 v232, s[28:31], s93 offen lds
    s_add_u32 s54, s54, 128
    s_cmp_eq_u32 s54, 896
    s_cselect_b32 s54, 0, s54
    buffer_load_dwordx4 v233, s[28:31], s93 offen offset:1024 lds
    buffer_load_dwordx4 v234, s[28:31], s93 offen offset:2048 lds
    buffer_load_dwordx4 v235, s[28:31], s93 offen offset:3072 lds
    s_waitcnt vmcnt(4)
    ds_read_b128 v[84:87], v239 offset:16384
    ds_read_b128 v[88:91], v240 offset:16384
    ds_read_b128 v[92:95], v241 offset:16384
    ds_read_b128 v[96:99], v242 offset:16384
    s_waitcnt lgkmcnt(0)
    s_add_u32 m0, s69, 16384
    s_add_u32 s93, s54, s55
    buffer_load_dwordx4 v232, s[28:31], s93 offen lds
    s_add_u32 s54, s54, 128
    s_cmp_eq_u32 s54, 896
    s_cselect_b32 s54, 0, s54
    buffer_load_dwordx4 v233, s[28:31], s93 offen offset:1024 lds
    buffer_load_dwordx4 v234, s[28:31], s93 offen offset:2048 lds
    buffer_load_dwordx4 v235, s[28:31], s93 offen offset:3072 lds
    s_waitcnt vmcnt(4)
    ds_read_b128 v[100:103], v239 offset:0
    ds_read_b128 v[104:107], v240 offset:0
    ds_read_b128 v[108:111], v241 offset:0
    ds_read_b128 v[112:115], v242 offset:0
    s_waitcnt lgkmcnt(0)
    s_add_u32 m0, s69, 0
    s_add_u32 s93, s54, s55
    buffer_load_dwordx4 v232, s[28:31], s93 offen lds
    s_add_u32 s54, s54, 128
    s_cmp_eq_u32 s54, 896
    s_cselect_b32 s54, 0, s54
    buffer_load_dwordx4 v233, s[28:31], s93 offen offset:1024 lds
    buffer_load_dwordx4 v234, s[28:31], s93 offen offset:2048 lds
    buffer_load_dwordx4 v235, s[28:31], s93 offen offset:3072 lds
    s_waitcnt vmcnt(4)
    ds_read_b128 v[116:119], v239 offset:16384
    ds_read_b128 v[120:123], v240 offset:16384
    ds_read_b128 v[124:127], v241 offset:16384
    ds_read_b128 v[128:131], v242 offset:16384
    s_waitcnt lgkmcnt(0)
    s_waitcnt vmcnt(0)
    ds_read_b128 v[132:135], v239 offset:0
    ds_read_b128 v[136:139], v240 offset:0
    ds_read_b128 v[140:143], v241 offset:0
    ds_read_b128 v[144:147], v242 offset:0
    s_waitcnt lgkmcnt(0)
    s_barrier
L_oq:
    s_lshl_b32 s5, s49, 6
    s_and_b32 s61, s48, 3
    s_add_u32 s5, s5, s61
    s_mul_i32 s5, s5, 2048
    s_add_u32 s5, s5, 13631488
    s_lshl_b32 s60, s50, 1
    s_add_u32 s60, s60, s78
    s_and_b32 s60, s60, 7
    s_lshl_b32 s72, s60, 15
    s_lshl_b32 s61, s61, 12
    s_add_u32 s72, s72, s61
    v_bfe_u32 v8, v1, 2, 2
    v_lshl_add_u32 v8, v8, 1, s60
    v_lshrrev_b32 v6, 5, v1
    v_add_u32 v8, v8, v6
    v_and_b32 v8, 7, v8
    v_bfe_u32 v6, v1, 4, 1
    v_lshl_add_u32 v8, v8, 1, v6
    v_mul_u32_u24 v8, 8192, v8
    s_mul_i32 s60, s50, 28
    s_add_u32 s61, s60, 27
    s_lshr_b32 s60, s60, 6
    s_lshr_b32 s61, s61, 6
    s_sub_u32 s61, s61, s60
    v_and_b32 v5, 1, v1
    v_mul_u32_u24 v5, s61, v5
    v_add_u32 v5, s60, v5
    v_bfe_u32 v6, v1, 1, 1
    v_mad_u32_u24 v5, v6, 7, v5
    v_add_u32 v9, 10, v5
    v_lshrrev_b32 v9, 4, v9
    v_lshrrev_b32 v7, 3, v5
    v_add3_u32 v5, v5, v9, v7
    s_sub_u32 s62, s61, 1
    s_and_b32 s62, s62, 0xaaaaaaaa
    s_mov_b32 s63, s62
    v_mad_u32_u24 v6, v6, 3, 6
    v_cndmask_b32 v5, v5, v6, s[62:63]
    v_lshl_add_u32 v17, v5, 7, v8
    s_lshl_b32 s68, s74, 18
    s_add_u32 s68, s68, 1048576
    s_mov_b32 s84, s78
    s_mov_b32 s64, -1
    s_mov_b32 s65, 0
    s_mov_b32 s90, 0x3e8b97f6
    s_mov_b32 s91, 0x3e8b97f6
    s_and_b32 s61, s48, 3
    v_mov_b32 v4, 0xdddddddd
    s_or_b32 s62, s61, 1
    s_add_u32 s60, s61, s62
    s_lshl_b32 s60, s60, 11
    s_add_u32 s60, s60, 65536
    s_lshl_b32 s62, s61, 11
    s_add_u32 s62, s62, 155648
    s_sub_u32 s60, s60, s62
    s_mul_i32 s60, s60, s78
    s_add_u32 s60, s60, s62
    v_and_b32 v5, 1, v1
    v_lshlrev_b32 v5, 4, v5
    v_bfe_u32 v6, v1, 4, 1
    v_lshl_add_u32 v5, v6, 3, v5
    v_bfe_u32 v6, v1, 3, 1
    v_lshl_add_u32 v5, v6, 1, v5
    v_bfe_u32 v6, v1, 1, 1
    v_add_u32 v5, v5, v6
    v_and_b32 v6, 0x24, v1
    v_add_u32 v5, v5, v6
    v_sub_u32 v5, v5, v1
    v_mul_lo_u32 v5, v5, s67
    v_add_u32 v5, v5, v1
    v_lshl_add_u32 v12, v5, 4, s60
    s_lshr_b32 s63, s61, 1
    s_and_b32 s62, s61, 1
    s_add_u32 s60, s63, 12
    s_lshl_b32 s62, s62, s60
    s_mul_i32 s63, s63, 4294879232
    s_add_u32 s62, s62, s63
    s_add_u32 s62, s62, 155648
    s_lshl_b32 s60, s78, 11
    s_sub_u32 s63, s62, s60
    s_add_u32 s62, s62, s60
    v_add_u32 v13, s63, v3
    v_add_u32 v29, s62, v3
    s_lshl_b32 s60, s78, 14
    v_add_u32 v14, s60, v3
    v_add_u32 v15, 0x10000, v14
    v_lshl_add_u32 v19, v1, 3, s60
    v_mov_b32 v246, 1073741824
    v_mov_b32 v247, 1073741824
    v_mov_b32 v248, 1073741824
    v_mov_b32 v249, 1073741824
    ds_read_b64_tr_b16 v[220:221], v245 offset:0
    ds_read_b64_tr_b16 v[222:223], v245 offset:256
    ds_read_b64_tr_b16 v[224:225], v245 offset:1024
    ds_read_b64_tr_b16 v[226:227], v245 offset:1280
    s_waitcnt lgkmcnt(2)
    s_waitcnt vmcnt(0)
    s_mov_b64 exec, 1
    buffer_store_dword v31, v3, s[36:39], s79 offen offset:0 sc1
    s_mov_b64 exec, -1
    v_mfma_f32_32x32x16_bf16 v[204:219], v[220:223], v[36:39], 0
    ds_read_b64_tr_b16 v[228:229], v245 offset:2048
    ds_read_b64_tr_b16 v[230:231], v245 offset:2304
    s_mov_b32 s42, 401408
    s_mov_b32 s43, 0x20000
    s_mov_b32 s44, s20
    s_mov_b32 s45, s21
    s_mov_b32 s46, 3670016
    s_waitcnt lgkmcnt(2)
    v_mfma_f32_32x32x16_bf16 v[204:219], v[224:227], v[40:43], v[204:219]
    ds_read_b64_tr_b16 v[220:221], v245 offset:3072
    ds_read_b64_tr_b16 v[222:223], v245 offset:3328
    s_mov_b32 s47, 0x20000
    s_mov_b32 s89, 1006632960
    s_and_b32 s77, s50, 3
    s_mul_i32 s77, s77, 224
    s_lshl_b32 s61, s49, 3
    s_waitcnt lgkmcnt(2)
    v_mfma_f32_32x32x16_bf16 v[204:219], v[228:231], v[44:47], v[204:219]
    ds_read_b64_tr_b16 v[224:225], v245 offset:4096
    ds_read_b64_tr_b16 v[226:227], v245 offset:4352
    s_add_u32 s61, s61, s51
    s_lshl_b32 s61, s61, 3
    s_lshr_b32 s60, s50, 2
    s_bfe_u32 s62, s48, 0x10001
    s_lshl_b32 s87, s62, 2
    s_waitcnt lgkmcnt(2)
    v_mfma_f32_32x32x16_bf16 v[204:219], v[220:223], v[48:51], v[204:219]
    ds_read_b64_tr_b16 v[228:229], v245 offset:5120
    ds_read_b64_tr_b16 v[230:231], v245 offset:5376
    s_add_u32 s87, s87, s60
    s_add_u32 s87, s87, s61
    s_mul_i32 s87, s87, 2048
    s_add_u32 s87, s87, 13631552
    s_lshl_b32 s63, s60, 1
    s_waitcnt lgkmcnt(2)
    v_mfma_f32_32x32x16_bf16 v[204:219], v[224:227], v[52:55], v[204:219]
    ds_read_b64_tr_b16 v[220:221], v245 offset:6144
    ds_read_b64_tr_b16 v[222:223], v245 offset:6400
    s_add_u32 s63, s63, s62
    s_add_u32 s63, s63, s61
    s_lshl_b32 s86, s63, 15
    s_add_u32 s86, s86, 9437184
    s_and_b32 s63, s48, 1
    s_waitcnt lgkmcnt(2)
    v_mfma_f32_32x32x16_bf16 v[204:219], v[228:231], v[56:59], v[204:219]
    ds_read_b64_tr_b16 v[224:225], v245 offset:7168
    ds_read_b64_tr_b16 v[226:227], v245 offset:7424
    s_lshl_b32 s63, s63, 8
    s_add_u32 s86, s86, s63
    s_lshl_b32 s63, s78, 11
    s_add_u32 s86, s86, s63
    s_lshl_b32 s61, s51, 2
    s_waitcnt lgkmcnt(2)
    v_mfma_f32_32x32x16_bf16 v[204:219], v[220:223], v[60:63], v[204:219]
    ds_read_b64_tr_b16 v[228:229], v245 offset:8192
    ds_read_b64_tr_b16 v[230:231], v245 offset:8448
    s_add_u32 s60, s60, s61
    s_lshl_b32 s60, s60, 2
    s_and_b32 s61, s48, 3
    s_add_u32 s60, s60, s61
    s_mul_i32 s88, s60, 28672
    s_waitcnt lgkmcnt(2)
    v_mfma_f32_32x32x16_bf16 v[204:219], v[224:227], v[64:67], v[204:219]
    ds_read_b64_tr_b16 v[220:221], v245 offset:9216
    ds_read_b64_tr_b16 v[222:223], v245 offset:9472
    s_mul_i32 s60, s49, 896
    s_add_u32 s88, s88, s60
    s_add_u32 s88, s88, s77
    v_and_b32 v7, 7, v1
    s_add_u32 s60, s61, 5
    s_waitcnt lgkmcnt(2)
    v_mfma_f32_32x32x16_bf16 v[204:219], v[228:231], v[68:71], v[204:219]
    ds_read_b64_tr_b16 v[224:225], v245 offset:10240
    ds_read_b64_tr_b16 v[226:227], v245 offset:10496
    s_lshl_b32 s60, s60, 13
    s_and_b32 s60, s60, 0xffff
    v_add_u32 v24, s60, v3
    s_lshl_b32 s62, s61, 2
    s_add_u32 s62, s62, 161280
    s_waitcnt lgkmcnt(2)
    v_mfma_f32_32x32x16_bf16 v[204:219], v[220:223], v[72:75], v[204:219]
    ds_read_b64_tr_b16 v[228:229], v245 offset:11264
    ds_read_b64_tr_b16 v[230:231], v245 offset:11520
    v_mov_b32 v25, s62
    s_mul_i32 s62, s61, 3072
    s_add_u32 s62, s62, 16384
    v_add_u32 v23, s62, v3
    v_lshrrev_b32 v6, 3, v1
    s_waitcnt lgkmcnt(2)
    v_mfma_f32_32x32x16_bf16 v[204:219], v[224:227], v[76:79], v[204:219]
    ds_read_b64_tr_b16 v[220:221], v245 offset:12288
    ds_read_b64_tr_b16 v[222:223], v245 offset:12544
    s_lshl_b32 s62, s78, 11
    s_add_u32 s60, s60, s62
    s_add_u32 s60, s60, 4096
    v_xor_b32 v8, v6, v7
    v_lshlrev_b32 v8, 4, v8
    s_waitcnt lgkmcnt(2)
    v_mfma_f32_32x32x16_bf16 v[204:219], v[228:231], v[80:83], v[204:219]
    ds_read_b64_tr_b16 v[224:225], v245 offset:13312
    ds_read_b64_tr_b16 v[226:227], v245 offset:13568
    v_lshl_add_u32 v8, v6, 7, v8
    v_add_u32 v27, s60, v8
    s_and_b32 s9, s50, 3
    s_lshl_b32 s9, s9, 1
    s_lshl_b32 s62, s78, 3
    s_waitcnt lgkmcnt(2)
    v_mfma_f32_32x32x16_bf16 v[204:219], v[220:223], v[84:87], v[204:219]
    ds_read_b64_tr_b16 v[228:229], v245 offset:14336
    ds_read_b64_tr_b16 v[230:231], v245 offset:14592
    s_add_u32 s62, s62, s9
    v_add_u32 v9, s62, v7
    v_subrev_u32 v8, 14, v9
    v_min_u32 v9, v9, v8
    v_mul_u32_u24 v8, 1792, v6
    s_waitcnt lgkmcnt(2)
    v_mfma_f32_32x32x16_bf16 v[204:219], v[224:227], v[88:91], v[204:219]
    ds_read_b64_tr_b16 v[220:221], v245 offset:15360
    ds_read_b64_tr_b16 v[222:223], v245 offset:15616
    v_lshl_add_u32 v28, v9, 4, v8
    v_add_u32 v8, 2, v7
    v_lshrrev_b32 v8, 3, v8
    v_mul_u32_u24 v8, s78, v8
    v_lshl_add_u32 v28, v8, 30, v28
    s_waitcnt lgkmcnt(2)
    v_mfma_f32_32x32x16_bf16 v[204:219], v[228:231], v[92:95], v[204:219]
    ds_read_b64_tr_b16 v[224:225], v245 offset:16384
    ds_read_b64_tr_b16 v[226:227], v245 offset:16640
    v_and_b32 v5, 15, v1
    v_lshrrev_b32 v6, 4, v1
    v_lshrrev_b32 v8, 1, v6
    v_xor_b32 v8, v8, v7
    v_lshlrev_b32 v8, 4, v8
    s_waitcnt lgkmcnt(2)
    v_mfma_f32_32x32x16_bf16 v[204:219], v[220:223], v[96:99], v[204:219]
    ds_read_b64_tr_b16 v[228:229], v245 offset:17408
    ds_read_b64_tr_b16 v[230:231], v245 offset:17664
    v_lshl_add_u32 v8, v5, 7, v8
    v_and_b32 v9, 1, v6
    v_lshl_add_u32 v8, v9, 3, v8
    v_add_u32 v26, s60, v8
    v_lshlrev_b32 v18, 7, v5
    s_waitcnt lgkmcnt(2)
    v_mfma_f32_32x32x16_bf16 v[204:219], v[224:227], v[100:103], v[204:219]
    ds_read_b64_tr_b16 v[220:221], v245 offset:18432
    ds_read_b64_tr_b16 v[222:223], v245 offset:18688
    v_lshlrev_b32 v7, 12, v7
    v_add_u32 v30, 1776, v7
    v_lshlrev_b32 v7, 9, v6
    v_lshl_add_u32 v20, v5, 4, v7
    v_lshrrev_b32 v7, 1, v6
    s_waitcnt lgkmcnt(2)
    v_mfma_f32_32x32x16_bf16 v[204:219], v[228:231], v[104:107], v[204:219]
    ds_read_b64_tr_b16 v[224:225], v245 offset:19456
    ds_read_b64_tr_b16 v[226:227], v245 offset:19712
    v_lshlrev_b32 v7, 4, v7
    v_lshl_add_u32 v7, v9, 2, v7
    v_bfe_u32 v8, v1, 2, 2
    v_add_u32 v7, v7, v8
    v_mul_u32_u24 v7, 224, v7
    s_waitcnt lgkmcnt(2)
    v_mfma_f32_32x32x16_bf16 v[204:219], v[220:223], v[108:111], v[204:219]
    ds_read_b64_tr_b16 v[228:229], v245 offset:20480
    ds_read_b64_tr_b16 v[230:231], v245 offset:20736
    v_and_b32 v8, 3, v1
    v_lshl_add_u32 v7, v8, 3, v7
    v_add_u32 v8, 1, v6
    v_lshrrev_b32 v8, 2, v8
    v_mul_u32_u24 v8, 896, v8
    s_mov_b32 exec_lo, 15
    s_mov_b32 exec_hi, 15
    buffer_load_dword v34, v17, s[36:39], s5 offen sc1
    s_mov_b64 exec, -1
    s_waitcnt lgkmcnt(2)
    v_mfma_f32_32x32x16_bf16 v[204:219], v[224:227], v[112:115], v[204:219]
    ds_read_b64_tr_b16 v[220:221], v245 offset:21504
    ds_read_b64_tr_b16 v[222:223], v245 offset:21760
    v_sub_u32 v8, v7, v8
    s_mul_i32 s60, s78, 6272
    s_add_u32 s60, s60, 66944
    v_add_u32 v21, s60, v7
    s_add_u32 s60, s60, 1792
    s_waitcnt lgkmcnt(2)
    v_mfma_f32_32x32x16_bf16 v[204:219], v[228:231], v[116:119], v[204:219]
    ds_read_b64_tr_b16 v[224:225], v245 offset:22528
    ds_read_b64_tr_b16 v[226:227], v245 offset:22784
    v_add_u32 v22, s60, v8
    s_mul_i32 s13, s78, 4294839040
    s_add_u32 s13, s13, 87808
    v_mul_u32_u24 v7, 0x4925, v1
    v_lshrrev_b32 v7, 18, v7
    s_waitcnt lgkmcnt(2)
    v_mfma_f32_32x32x16_bf16 v[204:219], v[220:223], v[120:123], v[204:219]
    ds_read_b64_tr_b16 v[228:229], v245 offset:23552
    ds_read_b64_tr_b16 v[230:231], v245 offset:23808
    v_mul_u32_u24 v8, 14, v7
    v_sub_u32 v8, v1, v8
    v_add_u32 v8, s9, v8
    v_subrev_u32 v9, 14, v8
    v_min_u32 v8, v8, v9
    s_waitcnt lgkmcnt(2)
    v_mfma_f32_32x32x16_bf16 v[204:219], v[224:227], v[124:127], v[204:219]
    ds_read_b64_tr_b16 v[220:221], v245 offset:24576
    ds_read_b64_tr_b16 v[222:223], v245 offset:24832
    v_mul_u32_u24 v7, 896, v7
    v_lshl_add_u32 v16, v8, 4, v7
    s_mul_i32 s73, s48, 3584
    s_add_u32 s73, s73, s77
    s_mul_i32 s26, s48, 896
    s_waitcnt lgkmcnt(2)
    v_mfma_f32_32x32x16_bf16 v[204:219], v[228:231], v[128:131], v[204:219]
    ds_read_b64_tr_b16 v[224:225], v245 offset:25600
    ds_read_b64_tr_b16 v[226:227], v245 offset:25856
    s_add_u32 s27, s26, 31872
    s_max_u32 s60, s48, 1
    s_sub_u32 s60, s60, s48
    s_mul_i32 s60, s60, 128256
    s_add_u32 s27, s27, s60
    s_cmp_ge_u32 s84, 1
    s_cbranch_scc1 L_skip1
    s_call_b64 s[82:83], L_try
L_skip1:
    s_waitcnt lgkmcnt(2)
    v_mfma_f32_32x32x16_bf16 v[204:219], v[220:223], v[132:135], v[204:219]
    ds_read_b64_tr_b16 v[228:229], v245 offset:26624
    ds_read_b64_tr_b16 v[230:231], v245 offset:26880
    s_waitcnt lgkmcnt(2)
    v_mfma_f32_32x32x16_bf16 v[204:219], v[224:227], v[136:139], v[204:219]
    ds_read_b64_tr_b16 v[220:221], v245 offset:27648
    ds_read_b64_tr_b16 v[222:223], v245 offset:27904
    s_waitcnt lgkmcnt(2)
    v_mfma_f32_32x32x16_bf16 v[204:219], v[228:231], v[140:143], v[204:219]
    s_waitcnt lgkmcnt(0)
    v_mfma_f32_32x32x16_bf16 v[204:219], v[220:223], v[144:147], v[204:219]
    s_nop 1
    s_nop 3
    s_nop 3
    s_nop 1
    v_pk_mul_f32 v[204:205], v[204:205], s[90:91]
    v_pk_mul_f32 v[206:207], v[206:207], s[90:91]
    v_pk_mul_f32 v[208:209], v[208:209], s[90:91]
    v_pk_mul_f32 v[210:211], v[210:211], s[90:91]
    v_pk_mul_f32 v[212:213], v[212:213], s[90:91]
    v_pk_mul_f32 v[214:215], v[214:215], s[90:91]
    v_pk_mul_f32 v[216:217], v[216:217], s[90:91]
    v_pk_mul_f32 v[218:219], v[218:219], s[90:91]
    v_cvt_pk_bf16_f32 v196, v204, v205
    v_cvt_pk_bf16_f32 v197, v206, v207
    v_cvt_pk_bf16_f32 v198, v208, v209
    v_cvt_pk_bf16_f32 v199, v210, v211
    v_cvt_pk_bf16_f32 v200, v212, v213
    v_cvt_pk_bf16_f32 v201, v214, v215
    v_cvt_pk_bf16_f32 v202, v216, v217
    v_cvt_pk_bf16_f32 v203, v218, v219
    v_mov_b32 v10, 16640
    v_cndmask_b32 v203, 0, v203, s[64:65]
    v_cndmask_b32 v202, v10, v202, s[64:65]
    ds_write_b128 v12, v[196:199]
    ds_write_b128 v12, v[200:203] offset:1024
    s_mov_b32 s75, 0x40000
L_spin0:
    s_cmp_ge_u32 s84, 1
    s_cbranch_scc1 L_spin0_done
    s_call_b64 s[82:83], L_try
    s_sub_u32 s75, s75, 1
    s_cbranch_scc0 L_spin0
L_spin0_done:
    s_waitcnt vmcnt(1) lgkmcnt(0)
    s_branch L_b0
L_try:
    s_waitcnt vmcnt(0)
    v_cmp_ne_u32 vcc, s52, v34
    s_nop 0
    s_or_b32 s94, vcc_lo, vcc_hi
    s_and_b32 s94, s94, 15
    s_cbranch_scc0 L_try0
    s_mov_b32 exec_lo, 15
    s_mov_b32 exec_hi, 15
    buffer_load_dword v34, v17, s[36:39], s5 offen sc1
    s_mov_b64 exec, -1
    s_setpc_b64 s[82:83]
L_try0:
    s_add_u32 m0, s57, 32768
    s_add_u32 s93, s72, s68
    buffer_load_dwordx4 v3, s[36:39], s93 offen offset:0 sc1 lds
    buffer_load_dwordx4 v3, s[36:39], s93 offen offset:1024 sc1 lds
    buffer_load_dwordx4 v3, s[36:39], s93 offen offset:2048 sc1 lds
    buffer_load_dwordx4 v3, s[36:39], s93 offen offset:3072 sc1 lds
    s_add_u32 s93, s72, 32768
    s_and_b32 s93, s93, 262143
    s_add_u32 m0, s57, 49152
    s_add_u32 s93, s93, s68
    buffer_load_dwordx4 v3, s[36:39], s93 offen offset:0 sc1 lds
    buffer_load_dwordx4 v3, s[36:39], s93 offen offset:1024 sc1 lds
    buffer_load_dwordx4 v3, s[36:39], s93 offen offset:2048 sc1 lds
    buffer_load_dwordx4 v3, s[36:39], s93 offen offset:3072 sc1 lds
    s_mov_b32 s84, 1
    s_mov_b64 exec, 0xffff
    buffer_load_dword v34, v17, s[36:39], s5 offen sc1
    s_mov_b64 exec, -1
    s_setpc_b64 s[82:83]
L_b0:
    s_barrier
    ds_read_b128 v[68:71], v13 offset:2048
    ds_read2st64_b64 v[148:151], v19 offset0:64 offset1:65
    ds_read_b128 v[72:75], v13 offset:3072
    ds_read2st64_b64 v[152:155], v19 offset0:66 offset1:67
    v_mov_b32 v36, 0
    v_mov_b32 v37, 0
    v_mov_b32 v38, 0
    v_mov_b32 v39, 0
    v_mov_b32 v40, 0
    v_mov_b32 v41, 0
    v_mov_b32 v42, 0
    v_mov_b32 v43, 0
    v_mov_b32 v44, 0
    v_mov_b32 v45, 0
    v_mov_b32 v46, 0
    v_mov_b32 v47, 0
    v_mov_b32 v48, 0
    v_mov_b32 v49, 0
    v_mov_b32 v50, 0
    v_mov_b32 v51, 0
    v_mov_b32 v52, 0
    v_mov_b32 v53, 0
    v_mov_b32 v54, 0
    v_mov_b32 v55, 0
    v_mov_b32 v56, 0
    v_mov_b32 v57, 0
    v_mov_b32 v58, 0
    v_mov_b32 v59, 0
    ds_read_b128 v[76:79], v29
    ds_read_b128 v[80:83], v29 offset:1024
    s_waitcnt lgkmcnt(4)
    v_mfma_f32_32x32x16_bf16 v[84:99], v[148:151], v[68:71], 4.0
    s_waitcnt lgkmcnt(2)
    v_mfma_f32_32x32x16_bf16 v[84:99], v[152:155], v[72:75], v[84:99]
    ds_read2st64_b64 v[156:159], v19 offset0:72 offset1:73
    ds_read2st64_b64 v[160:163], v19 offset0:74 offset1:75
    ds_read_b128 v[164:167], v14 offset:34816
    ds_read_b128 v[168:171], v14 offset:35840
    v_mov_b32 v60, 0
    v_mov_b32 v61, 0
    v_mov_b32 v62, 0
    v_mov_b32 v63, 0
    v_mov_b32 v64, 0
    v_mov_b32 v65, 0
    v_mov_b32 v66, 0
    v_mov_b32 v67, 0
    s_waitcnt lgkmcnt(4)
    v_mfma_f32_32x32x16_bf16 v[100:115], v[152:155], v[80:83], 4.0
    s_setprio 3
    v_exp_f32 v84, v84
    v_exp_f32 v85, v85
    v_exp_f32 v86, v86
    v_exp_f32 v87, v87
    v_mfma_f32_32x32x16_bf16 v[100:115], v[148:151], v[76:79], v[100:115]
    v_exp_f32 v88, v88
    v_exp_f32 v89, v89
    v_exp_f32 v90, v90
    v_exp_f32 v91, v91
    s_waitcnt vmcnt(0)
    v_cmp_ne_u32 vcc, s52, v34
    s_nop 0
    s_and_b32 s94, vcc_lo, 0xffff
    s_cbranch_scc1 L_polll
L_polll_done:
    v_exp_f32 v92, v92
    v_exp_f32 v93, v93
    v_exp_f32 v94, v94
    v_exp_f32 v95, v95
    s_add_u32 s72, s72, 65536
    s_and_b32 s72, s72, 0x3ffff
    s_add_u32 m0, s57, 0
    s_add_u32 s93, s72, s68
    buffer_load_dwordx4 v3, s[36:39], s93 offen offset:0 sc1 lds
    v_exp_f32 v96, v96
    v_exp_f32 v97, v97
    v_exp_f32 v98, v98
    v_exp_f32 v99, v99
    s_waitcnt lgkmcnt(0)
    v_mfma_f32_32x32x16_bf16 v[116:131], v[160:163], v[72:75], 4.0
    ds_read2st64_b64 v[148:151], v19 offset0:80 offset1:81
    buffer_load_dwordx4 v3, s[36:39], s93 offen offset:1024 sc1 lds
    v_exp_f32 v100, v100
    v_exp_f32 v101, v101
    v_exp_f32 v102, v102
    v_exp_f32 v103, v103
    v_mfma_f32_32x32x16_bf16 v[116:131], v[156:159], v[68:71], v[116:131]
    ds_read2st64_b64 v[152:155], v19 offset0:82 offset1:83
    buffer_load_dwordx4 v3, s[36:39], s93 offen offset:2048 sc1 lds
    v_exp_f32 v104, v104
    v_exp_f32 v105, v105
    v_exp_f32 v106, v106
    v_exp_f32 v107, v107
    v_smfmac_f32_32x32x32_bf16 v[36:51], v[164:167], v[84:91], v4
    ds_read_b128 v[172:175], v14 offset:38912
    buffer_load_dwordx4 v3, s[36:39], s93 offen offset:3072 sc1 lds
    v_exp_f32 v108, v108
    v_exp_f32 v109, v109
    v_exp_f32 v110, v110
    v_exp_f32 v111, v111
    v_smfmac_f32_32x32x32_bf16 v[36:51], v[168:171], v[92:99], v4
    ds_read_b128 v[176:179], v14 offset:39936
    v_exp_f32 v112, v112
    v_exp_f32 v113, v113
    v_exp_f32 v114, v114
    v_exp_f32 v115, v115
    v_mfma_f32_32x32x16_bf16 v[132:147], v[160:163], v[80:83], 4.0
    s_setprio 2
    buffer_store_dwordx4 v[180:183], v246, s[36:39], s92 offen offset:0 sc1
    v_exp_f32 v116, v116
    v_exp_f32 v117, v117
    v_exp_f32 v118, v118
    v_exp_f32 v119, v119
    v_mfma_f32_32x32x16_bf16 v[132:147], v[156:159], v[76:79], v[132:147]
    buffer_store_dwordx4 v[184:187], v247, s[36:39], s92 offen offset:0 sc1
    v_exp_f32 v120, v120
    v_exp_f32 v121, v121
    v_exp_f32 v122, v122
    v_exp_f32 v123, v123
    v_smfmac_f32_32x32x32_bf16 v[52:67], v[164:167], v[100:107], v4
    buffer_store_dwordx4 v[188:191], v248, s[36:39], s92 offen offset:0 sc1
    v_exp_f32 v124, v124
    v_exp_f32 v125, v125
    v_exp_f32 v126, v126
    v_exp_f32 v127, v127
    v_smfmac_f32_32x32x32_bf16 v[52:67], v[168:171], v[108:115], v4
    buffer_store_dwordx4 v[192:195], v249, s[36:39], s92 offen offset:0 sc1
    v_exp_f32 v128, v128
    v_exp_f32 v129, v129
    v_exp_f32 v130, v130
    v_exp_f32 v131, v131
    s_waitcnt lgkmcnt(0)
    v_mfma_f32_32x32x16_bf16 v[84:99], v[152:155], v[72:75], 4.0
    ds_read2st64_b64 v[156:159], v19 offset0:88 offset1:89
    v_exp_f32 v132, v132
    v_exp_f32 v133, v133
    v_exp_f32 v134, v134
    v_exp_f32 v135, v135
    v_mfma_f32_32x32x16_bf16 v[84:99], v[148:151], v[68:71], v[84:99]
    ds_read2st64_b64 v[160:163], v19 offset0:90 offset1:91
    v_exp_f32 v136, v136
    v_exp_f32 v137, v137
    v_exp_f32 v138, v138
    v_exp_f32 v139, v139
    v_smfmac_f32_32x32x32_bf16 v[36:51], v[172:175], v[116:123], v4
    ds_read_b128 v[164:167], v14 offset:43008
    s_setprio 1
    v_exp_f32 v140, v140
    v_exp_f32 v141, v141
    v_exp_f32 v142, v142
    v_exp_f32 v143, v143
    v_smfmac_f32_32x32x32_bf16 v[36:51], v[176:179], v[124:131], v4
    ds_read_b128 v[168:171], v14 offset:44032
    v_exp_f32 v144, v144
    v_exp_f32 v145, v145
    v_exp_f32 v146, v146
    v_exp_f32 v147, v147
    v_mfma_f32_32x32x16_bf16 v[100:115], v[152:155], v[80:83], 4.0
    v_exp_f32 v84, v84
    v_exp_f32 v85, v85
    v_exp_f32 v86, v86
    v_exp_f32 v87, v87
    v_mfma_f32_32x32x16_bf16 v[100:115], v[148:151], v[76:79], v[100:115]
    v_exp_f32 v88, v88
    v_exp_f32 v89, v89
    v_exp_f32 v90, v90
    v_exp_f32 v91, v91
    v_smfmac_f32_32x32x32_bf16 v[52:67], v[172:175], v[132:139], v4
    v_exp_f32 v92, v92
    v_exp_f32 v93, v93
    v_exp_f32 v94, v94
    v_exp_f32 v95, v95
    v_smfmac_f32_32x32x32_bf16 v[52:67], v[176:179], v[140:147], v4
    s_setprio 0
    v_exp_f32 v96, v96
    v_exp_f32 v97, v97
    v_exp_f32 v98, v98
    v_exp_f32 v99, v99
    s_waitcnt vmcnt(4) lgkmcnt(0)
    s_barrier
    v_mfma_f32_32x32x16_bf16 v[116:131], v[160:163], v[72:75], 4.0
    ds_read2st64_b64 v[148:151], v19 offset0:0 offset1:1
    s_setprio 3
    v_exp_f32 v100, v100
    v_exp_f32 v101, v101
    v_exp_f32 v102, v102
    v_exp_f32 v103, v103
    v_mfma_f32_32x32x16_bf16 v[116:131], v[156:159], v[68:71], v[116:131]
    ds_read2st64_b64 v[152:155], v19 offset0:2 offset1:3
    v_exp_f32 v104, v104
    v_exp_f32 v105, v105
    v_exp_f32 v106, v106
    v_exp_f32 v107, v107
    v_smfmac_f32_32x32x32_bf16 v[36:51], v[164:167], v[84:91], v4
    ds_read_b128 v[172:175], v14 offset:47104
    v_exp_f32 v108, v108
    v_exp_f32 v109, v109
    v_exp_f32 v110, v110
    v_exp_f32 v111, v111
    v_smfmac_f32_32x32x32_bf16 v[36:51], v[168:171], v[92:99], v4
    ds_read_b128 v[176:179], v14 offset:48128
    v_exp_f32 v112, v112
    v_exp_f32 v113, v113
    v_exp_f32 v114, v114
    v_exp_f32 v115, v115
    v_mfma_f32_32x32x16_bf16 v[132:147], v[160:163], v[80:83], 4.0
    s_waitcnt vmcnt(0)
    s_mov_b64 exec, 1
    buffer_store_dword v31, v3, s[36:39], s79 offen offset:0 sc1
    s_mov_b64 exec, -1
    v_exp_f32 v116, v116
    v_exp_f32 v117, v117
    v_exp_f32 v118, v118
    v_exp_f32 v119, v119
    v_mfma_f32_32x32x16_bf16 v[132:147], v[156:159], v[76:79], v[132:147]
    s_add_u32 s72, s72, 65536
    s_and_b32 s72, s72, 0x3ffff
    s_add_u32 m0, s57, 65536
    s_add_u32 s93, s72, s68
    buffer_load_dwordx4 v3, s[36:39], s93 offen offset:0 sc1 lds
    v_exp_f32 v120, v120
    v_exp_f32 v121, v121
    v_exp_f32 v122, v122
    v_exp_f32 v123, v123
    v_smfmac_f32_32x32x32_bf16 v[52:67], v[164:167], v[100:107], v4
    v_exp_f32 v124, v124
    v_exp_f32 v125, v125
    v_exp_f32 v126, v126
    v_exp_f32 v127, v127
    v_smfmac_f32_32x32x32_bf16 v[52:67], v[168:171], v[108:115], v4
    buffer_load_dwordx4 v3, s[36:39], s93 offen offset:1024 sc1 lds
    v_exp_f32 v128, v128
    v_exp_f32 v129, v129
    v_exp_f32 v130, v130
    v_exp_f32 v131, v131
    s_waitcnt lgkmcnt(0)
    v_mfma_f32_32x32x16_bf16 v[84:99], v[152:155], v[72:75], 4.0
    ds_read2st64_b64 v[156:159], v19 offset0:8 offset1:9
    v_exp_f32 v132, v132
    v_exp_f32 v133, v133
    v_exp_f32 v134, v134
    v_exp_f32 v135, v135
    v_mfma_f32_32x32x16_bf16 v[84:99], v[148:151], v[68:71], v[84:99]
    ds_read2st64_b64 v[160:163], v19 offset0:10 offset1:11
    v_exp_f32 v136, v136
    v_exp_f32 v137, v137
    v_exp_f32 v138, v138
    v_exp_f32 v139, v139
    v_smfmac_f32_32x32x32_bf16 v[36:51], v[172:175], v[116:123], v4
    ds_read_b128 v[164:167], v14 offset:2048
    v_exp_f32 v140, v140
    v_exp_f32 v141, v141
    v_exp_f32 v142, v142
    v_exp_f32 v143, v143
    v_smfmac_f32_32x32x32_bf16 v[36:51], v[176:179], v[124:131], v4
    ds_read_b128 v[168:171], v14 offset:3072
    v_exp_f32 v144, v144
    v_exp_f32 v145, v145
    v_exp_f32 v146, v146
    v_exp_f32 v147, v147
    v_mfma_f32_32x32x16_bf16 v[100:115], v[152:155], v[80:83], 4.0
    buffer_load_dwordx4 v3, s[36:39], s93 offen offset:2048 sc1 lds
    v_exp_f32 v84, v84
    v_exp_f32 v85, v85
    v_exp_f32 v86, v86
    v_exp_f32 v87, v87
    v_mfma_f32_32x32x16_bf16 v[100:115], v[148:151], v[76:79], v[100:115]
    v_exp_f32 v88, v88
    v_exp_f32 v89, v89
    v_exp_f32 v90, v90
    v_exp_f32 v91, v91
    v_smfmac_f32_32x32x32_bf16 v[52:67], v[172:175], v[132:139], v4
    buffer_load_dwordx4 v3, s[36:39], s93 offen offset:3072 sc1 lds
    v_exp_f32 v92, v92
    v_exp_f32 v93, v93
    v_exp_f32 v94, v94
    v_exp_f32 v95, v95
    v_smfmac_f32_32x32x32_bf16 v[52:67], v[176:179], v[140:147], v4
    s_setprio 2
    v_exp_f32 v96, v96
    v_exp_f32 v97, v97
    v_exp_f32 v98, v98
    v_exp_f32 v99, v99
    s_waitcnt lgkmcnt(0)
    v_mfma_f32_32x32x16_bf16 v[116:131], v[160:163], v[72:75], 4.0
    ds_read2st64_b64 v[148:151], v19 offset0:16 offset1:17
    v_exp_f32 v100, v100
    v_exp_f32 v101, v101
    v_exp_f32 v102, v102
    v_exp_f32 v103, v103
    v_mfma_f32_32x32x16_bf16 v[116:131], v[156:159], v[68:71], v[116:131]
    ds_read2st64_b64 v[152:155], v19 offset0:18 offset1:19
    v_mov_b32 v204, -1
    v_mov_b32 v205, -1
    v_mov_b32 v206, -1
    v_mov_b32 v207, -1
    v_exp_f32 v104, v104
    v_exp_f32 v105, v105
    v_exp_f32 v106, v106
    v_exp_f32 v107, v107
    v_smfmac_f32_32x32x32_bf16 v[36:51], v[164:167], v[84:91], v4
    ds_read_b128 v[172:175], v14 offset:6144
    v_exp_f32 v108, v108
    v_exp_f32 v109, v109
    v_exp_f32 v110, v110
    v_exp_f32 v111, v111
    v_smfmac_f32_32x32x32_bf16 v[36:51], v[168:171], v[92:99], v4
    ds_read_b128 v[176:179], v14 offset:7168
    v_exp_f32 v112, v112
    v_exp_f32 v113, v113
    v_exp_f32 v114, v114
    v_exp_f32 v115, v115
    v_mfma_f32_32x32x16_bf16 v[132:147], v[160:163], v[80:83], 4.0
    buffer_store_dwordx4 v[204:207], v3, s[36:39], s76 offen offset:0 sc1
    v_exp_f32 v116, v116
    v_exp_f32 v117, v117
    v_exp_f32 v118, v118
    v_exp_f32 v119, v119
    v_mfma_f32_32x32x16_bf16 v[132:147], v[156:159], v[76:79], v[132:147]
    v_exp_f32 v120, v120
    v_exp_f32 v121, v121
    v_exp_f32 v122, v122
    v_exp_f32 v123, v123
    v_smfmac_f32_32x32x32_bf16 v[52:67], v[164:167], v[100:107], v4
    buffer_store_dwordx4 v[204:207], v3, s[36:39], s76 offen offset:1024 sc1
    v_exp_f32 v124, v124
    v_exp_f32 v125, v125
    v_exp_f32 v126, v126
    v_exp_f32 v127, v127
    v_smfmac_f32_32x32x32_bf16 v[52:67], v[168:171], v[108:115], v4
    v_exp_f32 v128, v128
    v_exp_f32 v129, v129
    v_exp_f32 v130, v130
    v_exp_f32 v131, v131
    s_waitcnt lgkmcnt(0)
    v_mfma_f32_32x32x16_bf16 v[84:99], v[152:155], v[72:75], 4.0
    ds_read2st64_b64 v[156:159], v19 offset0:24 offset1:25
    v_exp_f32 v132, v132
    v_exp_f32 v133, v133
    v_exp_f32 v134, v134
    v_exp_f32 v135, v135
    v_mfma_f32_32x32x16_bf16 v[84:99], v[148:151], v[68:71], v[84:99]
    ds_read2st64_b64 v[160:163], v19 offset0:26 offset1:27
    s_setprio 1
    v_exp_f32 v136, v136
    v_exp_f32 v137, v137
    v_exp_f32 v138, v138
    v_exp_f32 v139, v139
    v_smfmac_f32_32x32x32_bf16 v[36:51], v[172:175], v[116:123], v4
    ds_read_b128 v[164:167], v14 offset:10240
    v_exp_f32 v140, v140
    v_exp_f32 v141, v141
    v_exp_f32 v142, v142
    v_exp_f32 v143, v143
    v_smfmac_f32_32x32x32_bf16 v[36:51], v[176:179], v[124:131], v4
    ds_read_b128 v[168:171], v14 offset:11264
    v_exp_f32 v144, v144
    v_exp_f32 v145, v145
    v_exp_f32 v146, v146
    v_exp_f32 v147, v147
    v_mfma_f32_32x32x16_bf16 v[100:115], v[152:155], v[80:83], 4.0
    v_exp_f32 v84, v84
    v_exp_f32 v85, v85
    v_exp_f32 v86, v86
    v_exp_f32 v87, v87
    v_mfma_f32_32x32x16_bf16 v[100:115], v[148:151], v[76:79], v[100:115]
    v_exp_f32 v88, v88
    v_exp_f32 v89, v89
    v_exp_f32 v90, v90
    v_exp_f32 v91, v91
    v_smfmac_f32_32x32x32_bf16 v[52:67], v[172:175], v[132:139], v4
    s_setprio 0
    v_exp_f32 v92, v92
    v_exp_f32 v93, v93
    v_exp_f32 v94, v94
    v_exp_f32 v95, v95
    v_smfmac_f32_32x32x32_bf16 v[52:67], v[176:179], v[140:147], v4
    s_waitcnt vmcnt(2) lgkmcnt(0)
    s_barrier
    s_setprio 3
    v_exp_f32 v96, v96
    v_exp_f32 v97, v97
    v_exp_f32 v98, v98
    v_exp_f32 v99, v99
    v_mfma_f32_32x32x16_bf16 v[116:131], v[160:163], v[72:75], 4.0
    ds_read2st64_b64 v[148:151], v19 offset0:128 offset1:129
    v_exp_f32 v100, v100
    v_exp_f32 v101, v101
    v_exp_f32 v102, v102
    v_exp_f32 v103, v103
    v_mfma_f32_32x32x16_bf16 v[116:131], v[156:159], v[68:71], v[116:131]
    ds_read2st64_b64 v[152:155], v19 offset0:130 offset1:131
    v_exp_f32 v104, v104
    v_exp_f32 v105, v105
    v_exp_f32 v106, v106
    v_exp_f32 v107, v107
    v_smfmac_f32_32x32x32_bf16 v[36:51], v[164:167], v[84:91], v4
    ds_read_b128 v[172:175], v14 offset:14336
    v_exp_f32 v108, v108
    v_exp_f32 v109, v109
    v_exp_f32 v110, v110
    v_exp_f32 v111, v111
    v_smfmac_f32_32x32x32_bf16 v[36:51], v[168:171], v[92:99], v4
    ds_read_b128 v[176:179], v14 offset:15360
    v_exp_f32 v112, v112
    v_exp_f32 v113, v113
    v_exp_f32 v114, v114
    v_exp_f32 v115, v115
    v_mfma_f32_32x32x16_bf16 v[132:147], v[160:163], v[80:83], 4.0
    v_exp_f32 v116, v116
    v_exp_f32 v117, v117
    v_exp_f32 v118, v118
    v_exp_f32 v119, v119
    v_mfma_f32_32x32x16_bf16 v[132:147], v[156:159], v[76:79], v[132:147]
    v_exp_f32 v120, v120
    v_exp_f32 v121, v121
    v_exp_f32 v122, v122
    v_exp_f32 v123, v123
    v_smfmac_f32_32x32x32_bf16 v[52:67], v[164:167], v[100:107], v4
    s_add_u32 s72, s72, 65536
    s_and_b32 s72, s72, 0x3ffff
    s_add_u32 m0, s57, 32768
    s_add_u32 s93, s72, s68
    buffer_load_dwordx4 v3, s[36:39], s93 offen offset:0 sc1 lds
    v_exp_f32 v124, v124
    v_exp_f32 v125, v125
    v_exp_f32 v126, v126
    v_exp_f32 v127, v127
    v_smfmac_f32_32x32x32_bf16 v[52:67], v[168:171], v[108:115], v4
    buffer_load_dwordx4 v3, s[36:39], s93 offen offset:1024 sc1 lds
    v_exp_f32 v128, v128
    v_exp_f32 v129, v129
    v_exp_f32 v130, v130
    v_exp_f32 v131, v131
    s_waitcnt lgkmcnt(0)
    v_mfma_f32_32x32x16_bf16 v[84:99], v[152:155], v[72:75], 4.0
    ds_read2st64_b64 v[156:159], v19 offset0:136 offset1:137
    v_exp_f32 v132, v132
    v_exp_f32 v133, v133
    v_exp_f32 v134, v134
    v_exp_f32 v135, v135
    v_mfma_f32_32x32x16_bf16 v[84:99], v[148:151], v[68:71], v[84:99]
    ds_read2st64_b64 v[160:163], v19 offset0:138 offset1:139
    v_exp_f32 v136, v136
    v_exp_f32 v137, v137
    v_exp_f32 v138, v138
    v_exp_f32 v139, v139
    v_smfmac_f32_32x32x32_bf16 v[36:51], v[172:175], v[116:123], v4
    ds_read_b128 v[164:167], v15 offset:2048
    v_exp_f32 v140, v140
    v_exp_f32 v141, v141
    v_exp_f32 v142, v142
    v_exp_f32 v143, v143
    v_smfmac_f32_32x32x32_bf16 v[36:51], v[176:179], v[124:131], v4
    ds_read_b128 v[168:171], v15 offset:3072
    v_exp_f32 v144, v144
    v_exp_f32 v145, v145
    v_exp_f32 v146, v146
    v_exp_f32 v147, v147
    v_mfma_f32_32x32x16_bf16 v[100:115], v[152:155], v[80:83], 4.0
    v_exp_f32 v84, v84
    v_exp_f32 v85, v85
    v_exp_f32 v86, v86
    v_exp_f32 v87, v87
    v_mfma_f32_32x32x16_bf16 v[100:115], v[148:151], v[76:79], v[100:115]
    v_exp_f32 v88, v88
    v_exp_f32 v89, v89
    v_exp_f32 v90, v90
    v_exp_f32 v91, v91
    v_smfmac_f32_32x32x32_bf16 v[52:67], v[172:175], v[132:139], v4
    buffer_load_dwordx4 v3, s[36:39], s93 offen offset:2048 sc1 lds
    v_exp_f32 v92, v92
    v_exp_f32 v93, v93
    v_exp_f32 v94, v94
    v_exp_f32 v95, v95
    v_smfmac_f32_32x32x32_bf16 v[52:67], v[176:179], v[140:147], v4
    s_setprio 2
    buffer_load_dwordx4 v3, s[36:39], s93 offen offset:3072 sc1 lds
    v_exp_f32 v96, v96
    v_exp_f32 v97, v97
    v_exp_f32 v98, v98
    v_exp_f32 v99, v99
    s_waitcnt lgkmcnt(0)
    v_mfma_f32_32x32x16_bf16 v[116:131], v[160:163], v[72:75], 4.0
    ds_read2st64_b64 v[148:151], v19 offset0:144 offset1:145
    v_exp_f32 v100, v100
    v_exp_f32 v101, v101
    v_exp_f32 v102, v102
    v_exp_f32 v103, v103
    v_mfma_f32_32x32x16_bf16 v[116:131], v[156:159], v[68:71], v[116:131]
    ds_read2st64_b64 v[152:155], v19 offset0:146 offset1:147
    s_mov_b64 exec, 0xffff0000
    buffer_load_dword v34, v17, s[36:39], s5 offen sc1
    s_mov_b64 exec, -1
    v_exp_f32 v104, v104
    v_exp_f32 v105, v105
    v_exp_f32 v106, v106
    v_exp_f32 v107, v107
    v_smfmac_f32_32x32x32_bf16 v[36:51], v[164:167], v[84:91], v4
    ds_read_b128 v[172:175], v15 offset:6144
    v_exp_f32 v108, v108
    v_exp_f32 v109, v109
    v_exp_f32 v110, v110
    v_exp_f32 v111, v111
    v_smfmac_f32_32x32x32_bf16 v[36:51], v[168:171], v[92:99], v4
    ds_read_b128 v[176:179], v15 offset:7168
    v_exp_f32 v112, v112
    v_exp_f32 v113, v113
    v_exp_f32 v114, v114
    v_exp_f32 v115, v115
    v_mfma_f32_32x32x16_bf16 v[132:147], v[160:163], v[80:83], 4.0
    s_add_u32 m0, s26, 102784
    s_add_u32 s94, s73, 143360
    buffer_load_dwordx4 v16, s[40:43], s94 offen lds
    v_exp_f32 v116, v116
    v_exp_f32 v117, v117
    v_exp_f32 v118, v118
    v_exp_f32 v119, v119
    v_mfma_f32_32x32x16_bf16 v[132:147], v[156:159], v[76:79], v[132:147]
    v_exp_f32 v120, v120
    v_exp_f32 v121, v121
    v_exp_f32 v122, v122
    v_exp_f32 v123, v123
    v_smfmac_f32_32x32x32_bf16 v[52:67], v[164:167], v[100:107], v4
    s_add_u32 m0, s26, 109952
    s_add_u32 s94, s73, 172032
    buffer_load_dwordx4 v16, s[40:43], s94 offen lds
    v_exp_f32 v124, v124
    v_exp_f32 v125, v125
    v_exp_f32 v126, v126
    v_exp_f32 v127, v127
    v_smfmac_f32_32x32x32_bf16 v[52:67], v[168:171], v[108:115], v4
    v_exp_f32 v128, v128
    v_exp_f32 v129, v129
    v_exp_f32 v130, v130
    v_exp_f32 v131, v131
    s_waitcnt lgkmcnt(0)
    v_mfma_f32_32x32x16_bf16 v[84:99], v[152:155], v[72:75], 4.0
    ds_read2st64_b64 v[156:159], v19 offset0:152 offset1:153
    v_exp_f32 v132, v132
    v_exp_f32 v133, v133
    v_exp_f32 v134, v134
    v_exp_f32 v135, v135
    v_mfma_f32_32x32x16_bf16 v[84:99], v[148:151], v[68:71], v[84:99]
    ds_read2st64_b64 v[160:163], v19 offset0:154 offset1:155
    s_setprio 1
    v_exp_f32 v136, v136
    v_exp_f32 v137, v137
    v_exp_f32 v138, v138
    v_exp_f32 v139, v139
    v_smfmac_f32_32x32x32_bf16 v[36:51], v[172:175], v[116:123], v4
    ds_read_b128 v[164:167], v15 offset:10240
    v_exp_f32 v140, v140
    v_exp_f32 v141, v141
    v_exp_f32 v142, v142
    v_exp_f32 v143, v143
    v_smfmac_f32_32x32x32_bf16 v[36:51], v[176:179], v[124:131], v4
    ds_read_b128 v[168:171], v15 offset:11264
    v_exp_f32 v144, v144
    v_exp_f32 v145, v145
    v_exp_f32 v146, v146
    v_exp_f32 v147, v147
    v_mfma_f32_32x32x16_bf16 v[100:115], v[152:155], v[80:83], 4.0
    v_exp_f32 v84, v84
    v_exp_f32 v85, v85
    v_exp_f32 v86, v86
    v_exp_f32 v87, v87
    v_mfma_f32_32x32x16_bf16 v[100:115], v[148:151], v[76:79], v[100:115]
    v_exp_f32 v88, v88
    v_exp_f32 v89, v89
    v_exp_f32 v90, v90
    v_exp_f32 v91, v91
    v_smfmac_f32_32x32x32_bf16 v[52:67], v[172:175], v[132:139], v4
    s_setprio 0
    v_exp_f32 v92, v92
    v_exp_f32 v93, v93
    v_exp_f32 v94, v94
    v_exp_f32 v95, v95
    v_smfmac_f32_32x32x32_bf16 v[52:67], v[176:179], v[140:147], v4
    s_waitcnt vmcnt(2) lgkmcnt(0)
    s_barrier
    s_setprio 3
    v_exp_f32 v96, v96
    v_exp_f32 v97, v97
    v_exp_f32 v98, v98
    v_exp_f32 v99, v99
    v_mfma_f32_32x32x16_bf16 v[116:131], v[160:163], v[72:75], 4.0
    ds_read2st64_b64 v[148:151], v19 offset0:64 offset1:65
    v_exp_f32 v100, v100
    v_exp_f32 v101, v101
    v_exp_f32 v102, v102
    v_exp_f32 v103, v103
    v_mfma_f32_32x32x16_bf16 v[116:131], v[156:159], v[68:71], v[116:131]
    ds_read2st64_b64 v[152:155], v19 offset0:66 offset1:67
    v_exp_f32 v104, v104
    v_exp_f32 v105, v105
    v_exp_f32 v106, v106
    v_exp_f32 v107, v107
    v_smfmac_f32_32x32x32_bf16 v[36:51], v[164:167], v[84:91], v4
    ds_read_b128 v[172:175], v15 offset:14336
    v_cmp_ne_u32 vcc, s52, v34
    s_nop 0
    s_and_b32 s94, vcc_lo, 0xffff0000
    s_cbranch_scc1 L_pollh
L_pollh_done:
    v_exp_f32 v108, v108
    v_exp_f32 v109, v109
    v_exp_f32 v110, v110
    v_exp_f32 v111, v111
    v_smfmac_f32_32x32x32_bf16 v[36:51], v[168:171], v[92:99], v4
    ds_read_b128 v[176:179], v15 offset:15360
    v_exp_f32 v112, v112
    v_exp_f32 v113, v113
    v_exp_f32 v114, v114
    v_exp_f32 v115, v115
    v_mfma_f32_32x32x16_bf16 v[132:147], v[160:163], v[80:83], 4.0
    v_exp_f32 v116, v116
    v_exp_f32 v117, v117
    v_exp_f32 v118, v118
    v_exp_f32 v119, v119
    v_mfma_f32_32x32x16_bf16 v[132:147], v[156:159], v[76:79], v[132:147]
    v_exp_f32 v120, v120
    v_exp_f32 v121, v121
    v_exp_f32 v122, v122
    v_exp_f32 v123, v123
    v_smfmac_f32_32x32x32_bf16 v[52:67], v[164:167], v[100:107], v4
    s_add_u32 s72, s72, 81920
    s_and_b32 s72, s72, 0x3ffff
    s_add_u32 m0, s57, 0
    s_add_u32 s93, s72, s68
    buffer_load_dwordx4 v3, s[36:39], s93 offen offset:0 sc1 lds
    v_exp_f32 v124, v124
    v_exp_f32 v125, v125
    v_exp_f32 v126, v126
    v_exp_f32 v127, v127
    v_smfmac_f32_32x32x32_bf16 v[52:67], v[168:171], v[108:115], v4
    buffer_load_dwordx4 v3, s[36:39], s93 offen offset:1024 sc1 lds
    v_exp_f32 v128, v128
    v_exp_f32 v129, v129
    v_exp_f32 v130, v130
    v_exp_f32 v131, v131
    s_waitcnt lgkmcnt(0)
    v_mfma_f32_32x32x16_bf16 v[84:99], v[152:155], v[72:75], 4.0
    ds_read2st64_b64 v[156:159], v19 offset0:72 offset1:73
    v_exp_f32 v132, v132
    v_exp_f32 v133, v133
    v_exp_f32 v134, v134
    v_exp_f32 v135, v135
    v_mfma_f32_32x32x16_bf16 v[84:99], v[148:151], v[68:71], v[84:99]
    ds_read2st64_b64 v[160:163], v19 offset0:74 offset1:75
    v_exp_f32 v136, v136
    v_exp_f32 v137, v137
    v_exp_f32 v138, v138
    v_exp_f32 v139, v139
    v_smfmac_f32_32x32x32_bf16 v[36:51], v[172:175], v[116:123], v4
    ds_read_b128 v[164:167], v14 offset:34816
    v_exp_f32 v140, v140
    v_exp_f32 v141, v141
    v_exp_f32 v142, v142
    v_exp_f32 v143, v143
    v_smfmac_f32_32x32x32_bf16 v[36:51], v[176:179], v[124:131], v4
    ds_read_b128 v[168:171], v14 offset:35840
    v_exp_f32 v144, v144
    v_exp_f32 v145, v145
    v_exp_f32 v146, v146
    v_exp_f32 v147, v147
    v_mfma_f32_32x32x16_bf16 v[100:115], v[152:155], v[80:83], 4.0
    v_exp_f32 v84, v84
    v_exp_f32 v85, v85
    v_exp_f32 v86, v86
    v_exp_f32 v87, v87
    v_mfma_f32_32x32x16_bf16 v[100:115], v[148:151], v[76:79], v[100:115]
    v_exp_f32 v88, v88
    v_exp_f32 v89, v89
    v_exp_f32 v90, v90
    v_exp_f32 v91, v91
    v_smfmac_f32_32x32x32_bf16 v[52:67], v[172:175], v[132:139], v4
    buffer_load_dwordx4 v3, s[36:39], s93 offen offset:2048 sc1 lds
    v_exp_f32 v92, v92
    v_exp_f32 v93, v93
    v_exp_f32 v94, v94
    v_exp_f32 v95, v95
    v_smfmac_f32_32x32x32_bf16 v[52:67], v[176:179], v[140:147], v4
    s_setprio 2
    buffer_load_dwordx4 v3, s[36:39], s93 offen offset:3072 sc1 lds
    v_exp_f32 v96, v96
    v_exp_f32 v97, v97
    v_exp_f32 v98, v98
    v_exp_f32 v99, v99
    s_waitcnt lgkmcnt(0)
    v_mfma_f32_32x32x16_bf16 v[116:131], v[160:163], v[72:75], 4.0
    ds_read2st64_b64 v[148:151], v19 offset0:80 offset1:81
    v_exp_f32 v100, v100
    v_exp_f32 v101, v101
    v_exp_f32 v102, v102
    v_exp_f32 v103, v103
    v_mfma_f32_32x32x16_bf16 v[116:131], v[156:159], v[68:71], v[116:131]
    ds_read2st64_b64 v[152:155], v19 offset0:82 offset1:83
    v_exp_f32 v104, v104
    v_exp_f32 v105, v105
    v_exp_f32 v106, v106
    v_exp_f32 v107, v107
    v_smfmac_f32_32x32x32_bf16 v[36:51], v[164:167], v[84:91], v4
    ds_read_b128 v[172:175], v14 offset:38912
    v_exp_f32 v108, v108
    v_exp_f32 v109, v109
    v_exp_f32 v110, v110
    v_exp_f32 v111, v111
    v_smfmac_f32_32x32x32_bf16 v[36:51], v[168:171], v[92:99], v4
    ds_read_b128 v[176:179], v14 offset:39936
    v_exp_f32 v112, v112
    v_exp_f32 v113, v113
    v_exp_f32 v114, v114
    v_exp_f32 v115, v115
    v_mfma_f32_32x32x16_bf16 v[132:147], v[160:163], v[80:83], 4.0
    s_add_u32 m0, s26, 117120
    s_add_u32 s94, s73, 200704
    buffer_load_dwordx4 v16, s[40:43], s94 offen lds
    v_exp_f32 v116, v116
    v_exp_f32 v117, v117
    v_exp_f32 v118, v118
    v_exp_f32 v119, v119
    v_mfma_f32_32x32x16_bf16 v[132:147], v[156:159], v[76:79], v[132:147]
    v_exp_f32 v120, v120
    v_exp_f32 v121, v121
    v_exp_f32 v122, v122
    v_exp_f32 v123, v123
    v_smfmac_f32_32x32x32_bf16 v[52:67], v[164:167], v[100:107], v4
    s_add_u32 m0, s26, 124288
    s_add_u32 s94, s73, 229376
    buffer_load_dwordx4 v16, s[40:43], s94 offen lds
    v_exp_f32 v124, v124
    v_exp_f32 v125, v125
    v_exp_f32 v126, v126
    v_exp_f32 v127, v127
    v_smfmac_f32_32x32x32_bf16 v[52:67], v[168:171], v[108:115], v4
    v_exp_f32 v128, v128
    v_exp_f32 v129, v129
    v_exp_f32 v130, v130
    v_exp_f32 v131, v131
    s_waitcnt lgkmcnt(0)
    v_mfma_f32_32x32x16_bf16 v[84:99], v[152:155], v[72:75], 4.0
    ds_read2st64_b64 v[156:159], v19 offset0:88 offset1:89
    v_exp_f32 v132, v132
    v_exp_f32 v133, v133
    v_exp_f32 v134, v134
    v_exp_f32 v135, v135
    v_mfma_f32_32x32x16_bf16 v[84:99], v[148:151], v[68:71], v[84:99]
    ds_read2st64_b64 v[160:163], v19 offset0:90 offset1:91
    s_setprio 1
    v_exp_f32 v136, v136
    v_exp_f32 v137, v137
    v_exp_f32 v138, v138
    v_exp_f32 v139, v139
    v_smfmac_f32_32x32x32_bf16 v[36:51], v[172:175], v[116:123], v4
    ds_read_b128 v[164:167], v14 offset:43008
    v_exp_f32 v140, v140
    v_exp_f32 v141, v141
    v_exp_f32 v142, v142
    v_exp_f32 v143, v143
    v_smfmac_f32_32x32x32_bf16 v[36:51], v[176:179], v[124:131], v4
    ds_read_b128 v[168:171], v14 offset:44032
    v_exp_f32 v144, v144
    v_exp_f32 v145, v145
    v_exp_f32 v146, v146
    v_exp_f32 v147, v147
    v_mfma_f32_32x32x16_bf16 v[100:115], v[152:155], v[80:83], 4.0
    v_exp_f32 v84, v84
    v_exp_f32 v85, v85
    v_exp_f32 v86, v86
    v_exp_f32 v87, v87
    v_mfma_f32_32x32x16_bf16 v[100:115], v[148:151], v[76:79], v[100:115]
    v_exp_f32 v88, v88
    v_exp_f32 v89, v89
    v_exp_f32 v90, v90
    v_exp_f32 v91, v91
    v_smfmac_f32_32x32x32_bf16 v[52:67], v[172:175], v[132:139], v4
    s_setprio 0
    v_exp_f32 v92, v92
    v_exp_f32 v93, v93
    v_exp_f32 v94, v94
    v_exp_f32 v95, v95
    v_smfmac_f32_32x32x32_bf16 v[52:67], v[176:179], v[140:147], v4
    s_waitcnt vmcnt(2) lgkmcnt(0)
    s_barrier
    s_setprio 3
    v_exp_f32 v96, v96
    v_exp_f32 v97, v97
    v_exp_f32 v98, v98
    v_exp_f32 v99, v99
    v_mfma_f32_32x32x16_bf16 v[116:131], v[160:163], v[72:75], 4.0
    ds_read2st64_b64 v[148:151], v19 offset0:0 offset1:1
    v_exp_f32 v100, v100
    v_exp_f32 v101, v101
    v_exp_f32 v102, v102
    v_exp_f32 v103, v103
    v_mfma_f32_32x32x16_bf16 v[116:131], v[156:159], v[68:71], v[116:131]
    ds_read2st64_b64 v[152:155], v19 offset0:2 offset1:3
    v_exp_f32 v104, v104
    v_exp_f32 v105, v105
    v_exp_f32 v106, v106
    v_exp_f32 v107, v107
    v_smfmac_f32_32x32x32_bf16 v[36:51], v[164:167], v[84:91], v4
    ds_read_b128 v[172:175], v14 offset:47104
    v_exp_f32 v108, v108
    v_exp_f32 v109, v109
    v_exp_f32 v110, v110
    v_exp_f32 v111, v111
    v_smfmac_f32_32x32x32_bf16 v[36:51], v[168:171], v[92:99], v4
    ds_read_b128 v[176:179], v14 offset:48128
    v_exp_f32 v112, v112
    v_exp_f32 v113, v113
    v_exp_f32 v114, v114
    v_exp_f32 v115, v115
    v_mfma_f32_32x32x16_bf16 v[132:147], v[160:163], v[80:83], 4.0
    v_exp_f32 v116, v116
    v_exp_f32 v117, v117
    v_exp_f32 v118, v118
    v_exp_f32 v119, v119
    v_mfma_f32_32x32x16_bf16 v[132:147], v[156:159], v[76:79], v[132:147]
    s_mov_b64 exec, 1
    buffer_store_dword v31, v3, s[36:39], s79 offen offset:64 sc1
    s_mov_b64 exec, -1
    v_exp_f32 v120, v120
    v_exp_f32 v121, v121
    v_exp_f32 v122, v122
    v_exp_f32 v123, v123
    v_smfmac_f32_32x32x32_bf16 v[52:67], v[164:167], v[100:107], v4
    s_add_u32 s72, s72, 65536
    s_and_b32 s72, s72, 0x3ffff
    s_add_u32 m0, s57, 65536
    s_add_u32 s93, s72, s68
    buffer_load_dwordx4 v3, s[36:39], s93 offen offset:0 sc1 lds
    v_exp_f32 v124, v124
    v_exp_f32 v125, v125
    v_exp_f32 v126, v126
    v_exp_f32 v127, v127
    v_smfmac_f32_32x32x32_bf16 v[52:67], v[168:171], v[108:115], v4
    buffer_load_dwordx4 v3, s[36:39], s93 offen offset:1024 sc1 lds
    v_exp_f32 v128, v128
    v_exp_f32 v129, v129
    v_exp_f32 v130, v130
    v_exp_f32 v131, v131
    s_waitcnt lgkmcnt(0)
    v_mfma_f32_32x32x16_bf16 v[84:99], v[152:155], v[72:75], 4.0
    ds_read2st64_b64 v[156:159], v19 offset0:8 offset1:9
    v_exp_f32 v132, v132
    v_exp_f32 v133, v133
    v_exp_f32 v134, v134
    v_exp_f32 v135, v135
    v_mfma_f32_32x32x16_bf16 v[84:99], v[148:151], v[68:71], v[84:99]
    ds_read2st64_b64 v[160:163], v19 offset0:10 offset1:11
    v_exp_f32 v136, v136
    v_exp_f32 v137, v137
    v_exp_f32 v138, v138
    v_exp_f32 v139, v139
    v_smfmac_f32_32x32x32_bf16 v[36:51], v[172:175], v[116:123], v4
    ds_read_b128 v[164:167], v14 offset:2048
    v_exp_f32 v140, v140
    v_exp_f32 v141, v141
    v_exp_f32 v142, v142
    v_exp_f32 v143, v143
    v_smfmac_f32_32x32x32_bf16 v[36:51], v[176:179], v[124:131], v4
    ds_read_b128 v[168:171], v14 offset:3072
    v_exp_f32 v144, v144
    v_exp_f32 v145, v145
    v_exp_f32 v146, v146
    v_exp_f32 v147, v147
    v_mfma_f32_32x32x16_bf16 v[100:115], v[152:155], v[80:83], 4.0
    v_exp_f32 v84, v84
    v_exp_f32 v85, v85
    v_exp_f32 v86, v86
    v_exp_f32 v87, v87
    v_mfma_f32_32x32x16_bf16 v[100:115], v[148:151], v[76:79], v[100:115]
    v_exp_f32 v88, v88
    v_exp_f32 v89, v89
    v_exp_f32 v90, v90
    v_exp_f32 v91, v91
    v_smfmac_f32_32x32x32_bf16 v[52:67], v[172:175], v[132:139], v4
    buffer_load_dwordx4 v3, s[36:39], s93 offen offset:2048 sc1 lds
    v_exp_f32 v92, v92
    v_exp_f32 v93, v93
    v_exp_f32 v94, v94
    v_exp_f32 v95, v95
    v_smfmac_f32_32x32x32_bf16 v[52:67], v[176:179], v[140:147], v4
    s_setprio 2
    buffer_load_dwordx4 v3, s[36:39], s93 offen offset:3072 sc1 lds
    v_exp_f32 v96, v96
    v_exp_f32 v97, v97
    v_exp_f32 v98, v98
    v_exp_f32 v99, v99
    s_waitcnt lgkmcnt(0)
    v_mfma_f32_32x32x16_bf16 v[116:131], v[160:163], v[72:75], 4.0
    ds_read2st64_b64 v[148:151], v19 offset0:16 offset1:17
    v_exp_f32 v100, v100
    v_exp_f32 v101, v101
    v_exp_f32 v102, v102
    v_exp_f32 v103, v103
    v_mfma_f32_32x32x16_bf16 v[116:131], v[156:159], v[68:71], v[116:131]
    ds_read2st64_b64 v[152:155], v19 offset0:18 offset1:19
    v_exp_f32 v104, v104
    v_exp_f32 v105, v105
    v_exp_f32 v106, v106
    v_exp_f32 v107, v107
    v_smfmac_f32_32x32x32_bf16 v[36:51], v[164:167], v[84:91], v4
    ds_read_b128 v[172:175], v14 offset:6144
    v_exp_f32 v108, v108
    v_exp_f32 v109, v109
    v_exp_f32 v110, v110
    v_exp_f32 v111, v111
    v_smfmac_f32_32x32x32_bf16 v[36:51], v[168:171], v[92:99], v4
    ds_read_b128 v[176:179], v14 offset:7168
    v_exp_f32 v112, v112
    v_exp_f32 v113, v113
    v_exp_f32 v114, v114
    v_exp_f32 v115, v115
    v_mfma_f32_32x32x16_bf16 v[132:147], v[160:163], v[80:83], 4.0
    s_add_u32 m0, s26, 131456
    s_add_u32 s94, s73, 258048
    buffer_load_dwordx4 v16, s[40:43], s94 offen lds
    v_exp_f32 v116, v116
    v_exp_f32 v117, v117
    v_exp_f32 v118, v118
    v_exp_f32 v119, v119
    v_mfma_f32_32x32x16_bf16 v[132:147], v[156:159], v[76:79], v[132:147]
    v_exp_f32 v120, v120
    v_exp_f32 v121, v121
    v_exp_f32 v122, v122
    v_exp_f32 v123, v123
    v_smfmac_f32_32x32x32_bf16 v[52:67], v[164:167], v[100:107], v4
    s_add_u32 m0, s26, 138624
    s_add_u32 s94, s73, 286720
    buffer_load_dwordx4 v16, s[40:43], s94 offen lds
    v_exp_f32 v124, v124
    v_exp_f32 v125, v125
    v_exp_f32 v126, v126
    v_exp_f32 v127, v127
    v_smfmac_f32_32x32x32_bf16 v[52:67], v[168:171], v[108:115], v4
    v_exp_f32 v128, v128
    v_exp_f32 v129, v129
    v_exp_f32 v130, v130
    v_exp_f32 v131, v131
    s_waitcnt lgkmcnt(0)
    v_mfma_f32_32x32x16_bf16 v[84:99], v[152:155], v[72:75], 4.0
    ds_read2st64_b64 v[156:159], v19 offset0:24 offset1:25
    v_exp_f32 v132, v132
    v_exp_f32 v133, v133
    v_exp_f32 v134, v134
    v_exp_f32 v135, v135
    v_mfma_f32_32x32x16_bf16 v[84:99], v[148:151], v[68:71], v[84:99]
    ds_read2st64_b64 v[160:163], v19 offset0:26 offset1:27
    s_setprio 1
    v_exp_f32 v136, v136
    v_exp_f32 v137, v137
    v_exp_f32 v138, v138
    v_exp_f32 v139, v139
    v_smfmac_f32_32x32x32_bf16 v[36:51], v[172:175], v[116:123], v4
    ds_read_b128 v[164:167], v14 offset:10240
    v_exp_f32 v140, v140
    v_exp_f32 v141, v141
    v_exp_f32 v142, v142
    v_exp_f32 v143, v143
    v_smfmac_f32_32x32x32_bf16 v[36:51], v[176:179], v[124:131], v4
    ds_read_b128 v[168:171], v14 offset:11264
    v_exp_f32 v144, v144
    v_exp_f32 v145, v145
    v_exp_f32 v146, v146
    v_exp_f32 v147, v147
    v_mfma_f32_32x32x16_bf16 v[100:115], v[152:155], v[80:83], 4.0
    v_exp_f32 v84, v84
    v_exp_f32 v85, v85
    v_exp_f32 v86, v86
    v_exp_f32 v87, v87
    v_mfma_f32_32x32x16_bf16 v[100:115], v[148:151], v[76:79], v[100:115]
    v_exp_f32 v88, v88
    v_exp_f32 v89, v89
    v_exp_f32 v90, v90
    v_exp_f32 v91, v91
    v_smfmac_f32_32x32x32_bf16 v[52:67], v[172:175], v[132:139], v4
    s_setprio 0
    v_exp_f32 v92, v92
    v_exp_f32 v93, v93
    v_exp_f32 v94, v94
    v_exp_f32 v95, v95
    v_smfmac_f32_32x32x32_bf16 v[52:67], v[176:179], v[140:147], v4
    s_waitcnt vmcnt(2) lgkmcnt(0)
    s_barrier
    s_setprio 3
    v_exp_f32 v96, v96
    v_exp_f32 v97, v97
    v_exp_f32 v98, v98
    v_exp_f32 v99, v99
    v_mfma_f32_32x32x16_bf16 v[116:131], v[160:163], v[72:75], 4.0
    ds_read2st64_b64 v[148:151], v19 offset0:128 offset1:129
    v_exp_f32 v100, v100
    v_exp_f32 v101, v101
    v_exp_f32 v102, v102
    v_exp_f32 v103, v103
    v_mfma_f32_32x32x16_bf16 v[116:131], v[156:159], v[68:71], v[116:131]
    ds_read2st64_b64 v[152:155], v19 offset0:130 offset1:131
    v_exp_f32 v104, v104
    v_exp_f32 v105, v105
    v_exp_f32 v106, v106
    v_exp_f32 v107, v107
    v_smfmac_f32_32x32x32_bf16 v[36:51], v[164:167], v[84:91], v4
    ds_read_b128 v[172:175], v14 offset:14336
    v_exp_f32 v108, v108
    v_exp_f32 v109, v109
    v_exp_f32 v110, v110
    v_exp_f32 v111, v111
    v_smfmac_f32_32x32x32_bf16 v[36:51], v[168:171], v[92:99], v4
    ds_read_b128 v[176:179], v14 offset:15360
    v_exp_f32 v112, v112
    v_exp_f32 v113, v113
    v_exp_f32 v114, v114
    v_exp_f32 v115, v115
    v_mfma_f32_32x32x16_bf16 v[132:147], v[160:163], v[80:83], 4.0
    v_exp_f32 v116, v116
    v_exp_f32 v117, v117
    v_exp_f32 v118, v118
    v_exp_f32 v119, v119
    v_mfma_f32_32x32x16_bf16 v[132:147], v[156:159], v[76:79], v[132:147]
    v_exp_f32 v120, v120
    v_exp_f32 v121, v121
    v_exp_f32 v122, v122
    v_exp_f32 v123, v123
    v_smfmac_f32_32x32x32_bf16 v[52:67], v[164:167], v[100:107], v4
    s_add_u32 s72, s72, 65536
    s_and_b32 s72, s72, 0x3ffff
    s_add_u32 m0, s57, 32768
    s_add_u32 s93, s72, s68
    buffer_load_dwordx4 v3, s[36:39], s93 offen offset:0 sc1 lds
    v_exp_f32 v124, v124
    v_exp_f32 v125, v125
    v_exp_f32 v126, v126
    v_exp_f32 v127, v127
    v_smfmac_f32_32x32x32_bf16 v[52:67], v[168:171], v[108:115], v4
    buffer_load_dwordx4 v3, s[36:39], s93 offen offset:1024 sc1 lds
    v_exp_f32 v128, v128
    v_exp_f32 v129, v129
    v_exp_f32 v130, v130
    v_exp_f32 v131, v131
    s_waitcnt lgkmcnt(0)
    v_mfma_f32_32x32x16_bf16 v[84:99], v[152:155], v[72:75], 4.0
    ds_read2st64_b64 v[156:159], v19 offset0:136 offset1:137
    v_exp_f32 v132, v132
    v_exp_f32 v133, v133
    v_exp_f32 v134, v134
    v_exp_f32 v135, v135
    v_mfma_f32_32x32x16_bf16 v[84:99], v[148:151], v[68:71], v[84:99]
    ds_read2st64_b64 v[160:163], v19 offset0:138 offset1:139
    v_exp_f32 v136, v136
    v_exp_f32 v137, v137
    v_exp_f32 v138, v138
    v_exp_f32 v139, v139
    v_smfmac_f32_32x32x32_bf16 v[36:51], v[172:175], v[116:123], v4
    ds_read_b128 v[164:167], v15 offset:2048
    v_exp_f32 v140, v140
    v_exp_f32 v141, v141
    v_exp_f32 v142, v142
    v_exp_f32 v143, v143
    v_smfmac_f32_32x32x32_bf16 v[36:51], v[176:179], v[124:131], v4
    ds_read_b128 v[168:171], v15 offset:3072
    v_exp_f32 v144, v144
    v_exp_f32 v145, v145
    v_exp_f32 v146, v146
    v_exp_f32 v147, v147
    v_mfma_f32_32x32x16_bf16 v[100:115], v[152:155], v[80:83], 4.0
    v_exp_f32 v84, v84
    v_exp_f32 v85, v85
    v_exp_f32 v86, v86
    v_exp_f32 v87, v87
    v_mfma_f32_32x32x16_bf16 v[100:115], v[148:151], v[76:79], v[100:115]
    v_lshrrev_b32 v5, 2, v3
    v_and_b32 v5, 60, v5
    v_add_u32 v5, 161280, v5
    v_mov_b32 v6, 0
    ds_write_b32 v5, v6
    v_exp_f32 v88, v88
    v_exp_f32 v89, v89
    v_exp_f32 v90, v90
    v_exp_f32 v91, v91
    v_smfmac_f32_32x32x32_bf16 v[52:67], v[172:175], v[132:139], v4
    buffer_load_dwordx4 v3, s[36:39], s93 offen offset:2048 sc1 lds
    v_exp_f32 v92, v92
    v_exp_f32 v93, v93
    v_exp_f32 v94, v94
    v_exp_f32 v95, v95
    v_smfmac_f32_32x32x32_bf16 v[52:67], v[176:179], v[140:147], v4
    s_setprio 2
    buffer_load_dwordx4 v3, s[36:39], s93 offen offset:3072 sc1 lds
    v_exp_f32 v96, v96
    v_exp_f32 v97, v97
    v_exp_f32 v98, v98
    v_exp_f32 v99, v99
    s_waitcnt lgkmcnt(0)
    v_mfma_f32_32x32x16_bf16 v[116:131], v[160:163], v[72:75], 4.0
    ds_read2st64_b64 v[148:151], v19 offset0:144 offset1:145
    v_exp_f32 v100, v100
    v_exp_f32 v101, v101
    v_exp_f32 v102, v102
    v_exp_f32 v103, v103
    v_mfma_f32_32x32x16_bf16 v[116:131], v[156:159], v[68:71], v[116:131]
    ds_read2st64_b64 v[152:155], v19 offset0:146 offset1:147
    v_exp_f32 v104, v104
    v_exp_f32 v105, v105
    v_exp_f32 v106, v106
    v_exp_f32 v107, v107
    v_smfmac_f32_32x32x32_bf16 v[36:51], v[164:167], v[84:91], v4
    ds_read_b128 v[172:175], v15 offset:6144
    v_exp_f32 v108, v108
    v_exp_f32 v109, v109
    v_exp_f32 v110, v110
    v_exp_f32 v111, v111
    v_smfmac_f32_32x32x32_bf16 v[36:51], v[168:171], v[92:99], v4
    ds_read_b128 v[176:179], v15 offset:7168
    v_exp_f32 v112, v112
    v_exp_f32 v113, v113
    v_exp_f32 v114, v114
    v_exp_f32 v115, v115
    v_mfma_f32_32x32x16_bf16 v[132:147], v[160:163], v[80:83], 4.0
    s_add_u32 m0, s26, 145792
    s_add_u32 s94, s73, 315392
    buffer_load_dwordx4 v16, s[40:43], s94 offen lds
    v_exp_f32 v116, v116
    v_exp_f32 v117, v117
    v_exp_f32 v118, v118
    v_exp_f32 v119, v119
    v_mfma_f32_32x32x16_bf16 v[132:147], v[156:159], v[76:79], v[132:147]
    v_exp_f32 v120, v120
    v_exp_f32 v121, v121
    v_exp_f32 v122, v122
    v_exp_f32 v123, v123
    v_smfmac_f32_32x32x32_bf16 v[52:67], v[164:167], v[100:107], v4
    s_add_u32 m0, s26, 152960
    s_add_u32 s94, s73, 344064
    buffer_load_dwordx4 v16, s[40:43], s94 offen lds
    v_exp_f32 v124, v124
    v_exp_f32 v125, v125
    v_exp_f32 v126, v126
    v_exp_f32 v127, v127
    v_smfmac_f32_32x32x32_bf16 v[52:67], v[168:171], v[108:115], v4
    v_exp_f32 v128, v128
    v_exp_f32 v129, v129
    v_exp_f32 v130, v130
    v_exp_f32 v131, v131
    s_waitcnt lgkmcnt(0)
    v_mfma_f32_32x32x16_bf16 v[84:99], v[152:155], v[72:75], 4.0
    ds_read2st64_b64 v[156:159], v19 offset0:152 offset1:153
    v_exp_f32 v132, v132
    v_exp_f32 v133, v133
    v_exp_f32 v134, v134
    v_exp_f32 v135, v135
    v_mfma_f32_32x32x16_bf16 v[84:99], v[148:151], v[68:71], v[84:99]
    ds_read2st64_b64 v[160:163], v19 offset0:154 offset1:155
    s_setprio 1
    v_exp_f32 v136, v136
    v_exp_f32 v137, v137
    v_exp_f32 v138, v138
    v_exp_f32 v139, v139
    v_smfmac_f32_32x32x32_bf16 v[36:51], v[172:175], v[116:123], v4
    ds_read_b128 v[164:167], v15 offset:10240
    v_exp_f32 v140, v140
    v_exp_f32 v141, v141
    v_exp_f32 v142, v142
    v_exp_f32 v143, v143
    v_smfmac_f32_32x32x32_bf16 v[36:51], v[176:179], v[124:131], v4
    ds_read_b128 v[168:171], v15 offset:11264
    v_exp_f32 v144, v144
    v_exp_f32 v145, v145
    v_exp_f32 v146, v146
    v_exp_f32 v147, v147
    v_mfma_f32_32x32x16_bf16 v[100:115], v[152:155], v[80:83], 4.0
    v_exp_f32 v84, v84
    v_exp_f32 v85, v85
    v_exp_f32 v86, v86
    v_exp_f32 v87, v87
    v_mfma_f32_32x32x16_bf16 v[100:115], v[148:151], v[76:79], v[100:115]
    s_lshl_b32 s60, s78, 12
    v_add_u32 v12, s60, v24
    v_xor_b32 v13, 0x1000, v12
    s_mul_i32 s60, s78, 48
    v_add_u32 v29, s60, v25
    v_xor_b32 v17, 48, v29
    v_mov_b32 v9, 1
    v_exp_f32 v88, v88
    v_exp_f32 v89, v89
    v_exp_f32 v90, v90
    v_exp_f32 v91, v91
    v_smfmac_f32_32x32x32_bf16 v[52:67], v[172:175], v[132:139], v4
    s_setprio 0
    v_exp_f32 v92, v92
    v_exp_f32 v93, v93
    v_exp_f32 v94, v94
    v_exp_f32 v95, v95
    v_smfmac_f32_32x32x32_bf16 v[52:67], v[176:179], v[140:147], v4
    s_waitcnt vmcnt(2) lgkmcnt(0)
    s_barrier
    s_setprio 3
    v_exp_f32 v96, v96
    v_exp_f32 v97, v97
    v_exp_f32 v98, v98
    v_exp_f32 v99, v99
    v_mfma_f32_32x32x16_bf16 v[116:131], v[160:163], v[72:75], 4.0
    ds_read2st64_b64 v[148:151], v19 offset0:64 offset1:65
    v_exp_f32 v100, v100
    v_exp_f32 v101, v101
    v_exp_f32 v102, v102
    v_exp_f32 v103, v103
    v_mfma_f32_32x32x16_bf16 v[116:131], v[156:159], v[68:71], v[116:131]
    ds_read2st64_b64 v[152:155], v19 offset0:66 offset1:67
    v_exp_f32 v104, v104
    v_exp_f32 v105, v105
    v_exp_f32 v106, v106
    v_exp_f32 v107, v107
    v_smfmac_f32_32x32x32_bf16 v[36:51], v[164:167], v[84:91], v4
    ds_read_b128 v[172:175], v15 offset:14336
    v_exp_f32 v108, v108
    v_exp_f32 v109, v109
    v_exp_f32 v110, v110
    v_exp_f32 v111, v111
    v_smfmac_f32_32x32x32_bf16 v[36:51], v[168:171], v[92:99], v4
    ds_read_b128 v[176:179], v15 offset:15360
    v_exp_f32 v112, v112
    v_exp_f32 v113, v113
    v_exp_f32 v114, v114
    v_exp_f32 v115, v115
    v_mfma_f32_32x32x16_bf16 v[132:147], v[160:163], v[80:83], 4.0
    v_exp_f32 v116, v116
    v_exp_f32 v117, v117
    v_exp_f32 v118, v118
    v_exp_f32 v119, v119
    v_mfma_f32_32x32x16_bf16 v[132:147], v[156:159], v[76:79], v[132:147]
    v_exp_f32 v120, v120
    v_exp_f32 v121, v121
    v_exp_f32 v122, v122
    v_exp_f32 v123, v123
    v_smfmac_f32_32x32x32_bf16 v[52:67], v[164:167], v[100:107], v4
    s_add_u32 s72, s72, 65536
    s_and_b32 s72, s72, 0x3ffff
    s_add_u32 m0, s57, 0
    s_add_u32 s93, s72, s68
    buffer_load_dwordx4 v3, s[36:39], s93 offen offset:0 sc1 lds
    v_exp_f32 v124, v124
    v_exp_f32 v125, v125
    v_exp_f32 v126, v126
    v_exp_f32 v127, v127
    v_smfmac_f32_32x32x32_bf16 v[52:67], v[168:171], v[108:115], v4
    buffer_load_dwordx4 v3, s[36:39], s93 offen offset:1024 sc1 lds
    v_exp_f32 v128, v128
    v_exp_f32 v129, v129
    v_exp_f32 v130, v130
    v_exp_f32 v131, v131
    s_waitcnt lgkmcnt(0)
    v_mfma_f32_32x32x16_bf16 v[84:99], v[152:155], v[72:75], 4.0
    ds_read2st64_b64 v[156:159], v19 offset0:72 offset1:73
    v_exp_f32 v132, v132
    v_exp_f32 v133, v133
    v_exp_f32 v134, v134
    v_exp_f32 v135, v135
    v_mfma_f32_32x32x16_bf16 v[84:99], v[148:151], v[68:71], v[84:99]
    ds_read2st64_b64 v[160:163], v19 offset0:74 offset1:75
    v_exp_f32 v136, v136
    v_exp_f32 v137, v137
    v_exp_f32 v138, v138
    v_exp_f32 v139, v139
    v_smfmac_f32_32x32x32_bf16 v[36:51], v[172:175], v[116:123], v4
    ds_read_b128 v[164:167], v14 offset:34816
    v_exp_f32 v140, v140
    v_exp_f32 v141, v141
    v_exp_f32 v142, v142
    v_exp_f32 v143, v143
    v_smfmac_f32_32x32x32_bf16 v[36:51], v[176:179], v[124:131], v4
    ds_read_b128 v[168:171], v14 offset:35840
    v_exp_f32 v144, v144
    v_exp_f32 v145, v145
    v_exp_f32 v146, v146
    v_exp_f32 v147, v147
    v_mfma_f32_32x32x16_bf16 v[100:115], v[152:155], v[80:83], 4.0
    v_exp_f32 v84, v84
    v_exp_f32 v85, v85
    v_exp_f32 v86, v86
    v_exp_f32 v87, v87
    v_mfma_f32_32x32x16_bf16 v[100:115], v[148:151], v[76:79], v[100:115]
    v_exp_f32 v88, v88
    v_exp_f32 v89, v89
    v_exp_f32 v90, v90
    v_exp_f32 v91, v91
    v_smfmac_f32_32x32x32_bf16 v[52:67], v[172:175], v[132:139], v4
    buffer_load_dwordx4 v3, s[36:39], s93 offen offset:2048 sc1 lds
    v_exp_f32 v92, v92
    v_exp_f32 v93, v93
    v_exp_f32 v94, v94
    v_exp_f32 v95, v95
    v_smfmac_f32_32x32x32_bf16 v[52:67], v[176:179], v[140:147], v4
    s_setprio 2
    buffer_load_dwordx4 v3, s[36:39], s93 offen offset:3072 sc1 lds
    v_exp_f32 v96, v96
    v_exp_f32 v97, v97
    v_exp_f32 v98, v98
    v_exp_f32 v99, v99
    s_waitcnt lgkmcnt(0)
    v_mfma_f32_32x32x16_bf16 v[116:131], v[160:163], v[72:75], 4.0
    ds_read2st64_b64 v[148:151], v19 offset0:80 offset1:81
    v_exp_f32 v100, v100
    v_exp_f32 v101, v101
    v_exp_f32 v102, v102
    v_exp_f32 v103, v103
    v_mfma_f32_32x32x16_bf16 v[116:131], v[156:159], v[68:71], v[116:131]
    ds_read2st64_b64 v[152:155], v19 offset0:82 offset1:83
    v_exp_f32 v104, v104
    v_exp_f32 v105, v105
    v_exp_f32 v106, v106
    v_exp_f32 v107, v107
    v_smfmac_f32_32x32x32_bf16 v[36:51], v[164:167], v[84:91], v4
    ds_read_b128 v[172:175], v14 offset:38912
    v_exp_f32 v108, v108
    v_exp_f32 v109, v109
    v_exp_f32 v110, v110
    v_exp_f32 v111, v111
    v_smfmac_f32_32x32x32_bf16 v[36:51], v[168:171], v[92:99], v4
    ds_read_b128 v[176:179], v14 offset:39936
    v_exp_f32 v112, v112
    v_exp_f32 v113, v113
    v_exp_f32 v114, v114
    v_exp_f32 v115, v115
    v_mfma_f32_32x32x16_bf16 v[132:147], v[160:163], v[80:83], 4.0
    buffer_load_dword v11, v18, s[36:39], s87 offen sc1
    v_exp_f32 v116, v116
    v_exp_f32 v117, v117
    v_exp_f32 v118, v118
    v_exp_f32 v119, v119
    v_mfma_f32_32x32x16_bf16 v[132:147], v[156:159], v[76:79], v[132:147]
    v_exp_f32 v120, v120
    v_exp_f32 v121, v121
    v_exp_f32 v122, v122
    v_exp_f32 v123, v123
    v_smfmac_f32_32x32x32_bf16 v[52:67], v[164:167], v[100:107], v4
    v_exp_f32 v124, v124
    v_exp_f32 v125, v125
    v_exp_f32 v126, v126
    v_exp_f32 v127, v127
    v_smfmac_f32_32x32x32_bf16 v[52:67], v[168:171], v[108:115], v4
    v_exp_f32 v128, v128
    v_exp_f32 v129, v129
    v_exp_f32 v130, v130
    v_exp_f32 v131, v131
    s_waitcnt lgkmcnt(0)
    v_mfma_f32_32x32x16_bf16 v[84:99], v[152:155], v[72:75], 4.0
    ds_read2st64_b64 v[156:159], v19 offset0:88 offset1:89
    v_exp_f32 v132, v132
    v_exp_f32 v133, v133
    v_exp_f32 v134, v134
    v_exp_f32 v135, v135
    v_mfma_f32_32x32x16_bf16 v[84:99], v[148:151], v[68:71], v[84:99]
    ds_read2st64_b64 v[160:163], v19 offset0:90 offset1:91
    s_setprio 1
    v_exp_f32 v136, v136
    v_exp_f32 v137, v137
    v_exp_f32 v138, v138
    v_exp_f32 v139, v139
    v_smfmac_f32_32x32x32_bf16 v[36:51], v[172:175], v[116:123], v4
    ds_read_b128 v[164:167], v14 offset:43008
    v_exp_f32 v140, v140
    v_exp_f32 v141, v141
    v_exp_f32 v142, v142
    v_exp_f32 v143, v143
    v_smfmac_f32_32x32x32_bf16 v[36:51], v[176:179], v[124:131], v4
    ds_read_b128 v[168:171], v14 offset:44032
    v_exp_f32 v144, v144
    v_exp_f32 v145, v145
    v_exp_f32 v146, v146
    v_exp_f32 v147, v147
    v_mfma_f32_32x32x16_bf16 v[100:115], v[152:155], v[80:83], 4.0
    v_exp_f32 v84, v84
    v_exp_f32 v85, v85
    v_exp_f32 v86, v86
    v_exp_f32 v87, v87
    v_mfma_f32_32x32x16_bf16 v[100:115], v[148:151], v[76:79], v[100:115]
    v_exp_f32 v88, v88
    v_exp_f32 v89, v89
    v_exp_f32 v90, v90
    v_exp_f32 v91, v91
    v_smfmac_f32_32x32x32_bf16 v[52:67], v[172:175], v[132:139], v4
    s_setprio 0
    v_exp_f32 v92, v92
    v_exp_f32 v93, v93
    v_exp_f32 v94, v94
    v_exp_f32 v95, v95
    v_smfmac_f32_32x32x32_bf16 v[52:67], v[176:179], v[140:147], v4
    s_waitcnt vmcnt(0) lgkmcnt(0)
    s_barrier
    s_setprio 3
    v_exp_f32 v96, v96
    v_exp_f32 v97, v97
    v_exp_f32 v98, v98
    v_exp_f32 v99, v99
    v_mfma_f32_32x32x16_bf16 v[116:131], v[160:163], v[72:75], 4.0
    ds_read2st64_b64 v[148:151], v19 offset0:0 offset1:1
    v_exp_f32 v100, v100
    v_exp_f32 v101, v101
    v_exp_f32 v102, v102
    v_exp_f32 v103, v103
    v_mfma_f32_32x32x16_bf16 v[116:131], v[156:159], v[68:71], v[116:131]
    ds_read2st64_b64 v[152:155], v19 offset0:2 offset1:3
    v_exp_f32 v104, v104
    v_exp_f32 v105, v105
    v_exp_f32 v106, v106
    v_exp_f32 v107, v107
    v_smfmac_f32_32x32x32_bf16 v[36:51], v[164:167], v[84:91], v4
    ds_read_b128 v[172:175], v14 offset:47104
    v_exp_f32 v108, v108
    v_exp_f32 v109, v109
    v_exp_f32 v110, v110
    v_exp_f32 v111, v111
    v_smfmac_f32_32x32x32_bf16 v[36:51], v[168:171], v[92:99], v4
    ds_read_b128 v[176:179], v14 offset:48128
    v_exp_f32 v112, v112
    v_exp_f32 v113, v113
    v_exp_f32 v114, v114
    v_exp_f32 v115, v115
    v_mfma_f32_32x32x16_bf16 v[132:147], v[160:163], v[80:83], 4.0
    s_add_u32 m0, s26, 66944
    s_add_u32 s94, s73, 0
    buffer_load_dwordx4 v16, s[40:43], s94 offen lds
    v_exp_f32 v116, v116
    v_exp_f32 v117, v117
    v_exp_f32 v118, v118
    v_exp_f32 v119, v119
    v_mfma_f32_32x32x16_bf16 v[132:147], v[156:159], v[76:79], v[132:147]
    v_exp_f32 v120, v120
    v_exp_f32 v121, v121
    v_exp_f32 v122, v122
    v_exp_f32 v123, v123
    v_smfmac_f32_32x32x32_bf16 v[52:67], v[164:167], v[100:107], v4
    s_add_u32 m0, s26, 74112
    s_add_u32 s94, s73, 28672
    buffer_load_dwordx4 v16, s[40:43], s94 offen lds
    v_exp_f32 v124, v124
    v_exp_f32 v125, v125
    v_exp_f32 v126, v126
    v_exp_f32 v127, v127
    v_smfmac_f32_32x32x32_bf16 v[52:67], v[168:171], v[108:115], v4
    v_exp_f32 v128, v128
    v_exp_f32 v129, v129
    v_exp_f32 v130, v130
    v_exp_f32 v131, v131
    s_waitcnt lgkmcnt(0)
    v_mfma_f32_32x32x16_bf16 v[84:99], v[152:155], v[72:75], 4.0
    ds_read2st64_b64 v[156:159], v19 offset0:8 offset1:9
    v_exp_f32 v132, v132
    v_exp_f32 v133, v133
    v_exp_f32 v134, v134
    v_exp_f32 v135, v135
    v_mfma_f32_32x32x16_bf16 v[84:99], v[148:151], v[68:71], v[84:99]
    ds_read2st64_b64 v[160:163], v19 offset0:10 offset1:11
    s_add_u32 m0, s26, 81280
    s_add_u32 s94, s73, 57344
    buffer_load_dwordx4 v16, s[40:43], s94 offen lds
    v_exp_f32 v136, v136
    v_exp_f32 v137, v137
    v_exp_f32 v138, v138
    v_exp_f32 v139, v139
    v_smfmac_f32_32x32x32_bf16 v[36:51], v[172:175], v[116:123], v4
    ds_read_b128 v[164:167], v14 offset:2048
    v_exp_f32 v140, v140
    v_exp_f32 v141, v141
    v_exp_f32 v142, v142
    v_exp_f32 v143, v143
    v_smfmac_f32_32x32x32_bf16 v[36:51], v[176:179], v[124:131], v4
    ds_read_b128 v[168:171], v14 offset:3072
    v_exp_f32 v144, v144
    v_exp_f32 v145, v145
    v_exp_f32 v146, v146
    v_exp_f32 v147, v147
    v_mfma_f32_32x32x16_bf16 v[100:115], v[152:155], v[80:83], 4.0
    s_add_u32 m0, s26, 88448
    s_add_u32 s94, s73, 86016
    buffer_load_dwordx4 v16, s[40:43], s94 offen lds
    v_exp_f32 v84, v84
    v_exp_f32 v85, v85
    v_exp_f32 v86, v86
    v_exp_f32 v87, v87
    v_mfma_f32_32x32x16_bf16 v[100:115], v[148:151], v[76:79], v[100:115]
    v_exp_f32 v88, v88
    v_exp_f32 v89, v89
    v_exp_f32 v90, v90
    v_exp_f32 v91, v91
    v_smfmac_f32_32x32x32_bf16 v[52:67], v[172:175], v[132:139], v4
    s_add_u32 m0, s26, 95616
    s_add_u32 s94, s73, 114688
    buffer_load_dwordx4 v16, s[40:43], s94 offen lds
    v_exp_f32 v92, v92
    v_exp_f32 v93, v93
    v_exp_f32 v94, v94
    v_exp_f32 v95, v95
    v_smfmac_f32_32x32x32_bf16 v[52:67], v[176:179], v[140:147], v4
    s_setprio 2
    v_exp_f32 v96, v96
    v_exp_f32 v97, v97
    v_exp_f32 v98, v98
    v_exp_f32 v99, v99
    s_waitcnt lgkmcnt(0)
    v_mfma_f32_32x32x16_bf16 v[116:131], v[160:163], v[72:75], 4.0
    ds_read2st64_b64 v[148:151], v19 offset0:16 offset1:17
    v_exp_f32 v100, v100
    v_exp_f32 v101, v101
    v_exp_f32 v102, v102
    v_exp_f32 v103, v103
    v_mfma_f32_32x32x16_bf16 v[116:131], v[156:159], v[68:71], v[116:131]
    ds_read2st64_b64 v[152:155], v19 offset0:18 offset1:19
    s_mov_b32 m0, s27
    s_add_u32 s94, s73, 372736
    buffer_load_dwordx4 v16, s[40:43], s94 offen lds
    v_exp_f32 v104, v104
    v_exp_f32 v105, v105
    v_exp_f32 v106, v106
    v_exp_f32 v107, v107
    v_smfmac_f32_32x32x32_bf16 v[36:51], v[164:167], v[84:91], v4
    ds_read_b128 v[172:175], v14 offset:6144
    v_exp_f32 v108, v108
    v_exp_f32 v109, v109
    v_exp_f32 v110, v110
    v_exp_f32 v111, v111
    v_smfmac_f32_32x32x32_bf16 v[36:51], v[168:171], v[92:99], v4
    ds_read_b128 v[176:179], v14 offset:7168
    v_exp_f32 v112, v112
    v_exp_f32 v113, v113
    v_exp_f32 v114, v114
    v_exp_f32 v115, v115
    v_mfma_f32_32x32x16_bf16 v[132:147], v[160:163], v[80:83], 4.0
    v_cmp_ne_u32 vcc, s52, v11
    s_nop 0
    s_and_b32 s94, vcc_lo, 0xffff
    s_cbranch_scc1 L_pollc
L_pollc_done:
    v_exp_f32 v116, v116
    v_exp_f32 v117, v117
    v_exp_f32 v118, v118
    v_exp_f32 v119, v119
    v_mfma_f32_32x32x16_bf16 v[132:147], v[156:159], v[76:79], v[132:147]
    v_exp_f32 v120, v120
    v_exp_f32 v121, v121
    v_exp_f32 v122, v122
    v_exp_f32 v123, v123
    v_smfmac_f32_32x32x32_bf16 v[52:67], v[164:167], v[100:107], v4
    s_or_b32 s60, s50, s51
    s_or_b32 s60, s60, s48
    s_cbranch_scc0 L_epoch
L_epd:
    v_exp_f32 v124, v124
    v_exp_f32 v125, v125
    v_exp_f32 v126, v126
    v_exp_f32 v127, v127
    v_smfmac_f32_32x32x32_bf16 v[52:67], v[168:171], v[108:115], v4
    v_exp_f32 v128, v128
    v_exp_f32 v129, v129
    v_exp_f32 v130, v130
    v_exp_f32 v131, v131
    s_waitcnt lgkmcnt(0)
    v_mfma_f32_32x32x16_bf16 v[84:99], v[152:155], v[72:75], 4.0
    ds_read2st64_b64 v[156:159], v19 offset0:24 offset1:25
    v_exp_f32 v132, v132
    v_exp_f32 v133, v133
    v_exp_f32 v134, v134
    v_exp_f32 v135, v135
    v_mfma_f32_32x32x16_bf16 v[84:99], v[148:151], v[68:71], v[84:99]
    ds_read2st64_b64 v[160:163], v19 offset0:26 offset1:27
    s_setprio 1
    v_exp_f32 v136, v136
    v_exp_f32 v137, v137
    v_exp_f32 v138, v138
    v_exp_f32 v139, v139
    v_smfmac_f32_32x32x32_bf16 v[36:51], v[172:175], v[116:123], v4
    ds_read_b128 v[164:167], v14 offset:10240
    v_exp_f32 v140, v140
    v_exp_f32 v141, v141
    v_exp_f32 v142, v142
    v_exp_f32 v143, v143
    v_smfmac_f32_32x32x32_bf16 v[36:51], v[176:179], v[124:131], v4
    ds_read_b128 v[168:171], v14 offset:11264
    v_exp_f32 v144, v144
    v_exp_f32 v145, v145
    v_exp_f32 v146, v146
    v_exp_f32 v147, v147
    s_waitcnt lgkmcnt(2)
    v_mfma_f32_32x32x16_bf16 v[100:115], v[160:163], v[72:75], 4.0
    v_exp_f32 v84, v84
    v_exp_f32 v85, v85
    v_exp_f32 v86, v86
    v_exp_f32 v87, v87
    v_mfma_f32_32x32x16_bf16 v[100:115], v[156:159], v[68:71], v[100:115]
    v_exp_f32 v88, v88
    v_exp_f32 v89, v89
    v_exp_f32 v90, v90
    v_exp_f32 v91, v91
    v_smfmac_f32_32x32x32_bf16 v[52:67], v[172:175], v[132:139], v4
    s_setprio 0
    v_exp_f32 v92, v92
    v_exp_f32 v93, v93
    v_exp_f32 v94, v94
    v_exp_f32 v95, v95
    v_smfmac_f32_32x32x32_bf16 v[52:67], v[176:179], v[140:147], v4
    v_exp_f32 v96, v96
    v_exp_f32 v97, v97
    v_exp_f32 v98, v98
    v_exp_f32 v99, v99
    s_waitcnt vmcnt(0) lgkmcnt(0)
    s_barrier
    v_mfma_f32_32x32x16_bf16 v[116:131], v[152:155], v[80:83], 4.0
    ds_read_b128 v[172:175], v14 offset:14336
    s_setprio 3
    v_exp_f32 v100, v100
    v_exp_f32 v101, v101
    v_exp_f32 v102, v102
    v_exp_f32 v103, v103
    v_mfma_f32_32x32x16_bf16 v[116:131], v[148:151], v[76:79], v[116:131]
    ds_read_b128 v[176:179], v14 offset:15360
    v_exp_f32 v104, v104
    v_exp_f32 v105, v105
    v_exp_f32 v106, v106
    v_exp_f32 v107, v107
    v_smfmac_f32_32x32x32_bf16 v[36:51], v[164:167], v[84:91], v4
    v_exp_f32 v108, v108
    v_exp_f32 v109, v109
    v_exp_f32 v110, v110
    v_exp_f32 v111, v111
    v_smfmac_f32_32x32x32_bf16 v[36:51], v[168:171], v[92:99], v4
    v_exp_f32 v112, v112
    v_exp_f32 v113, v113
    v_exp_f32 v114, v114
    v_exp_f32 v115, v115
    s_waitcnt lgkmcnt(0)
    v_mfma_f32_32x32x16_bf16 v[132:147], v[160:163], v[80:83], 4.0
    v_exp_f32 v116, v116
    v_exp_f32 v117, v117
    v_exp_f32 v118, v118
    v_exp_f32 v119, v119
    v_mfma_f32_32x32x16_bf16 v[132:147], v[156:159], v[76:79], v[132:147]
    v_exp_f32 v120, v120
    v_exp_f32 v121, v121
    v_exp_f32 v122, v122
    v_exp_f32 v123, v123
    v_smfmac_f32_32x32x32_bf16 v[36:51], v[172:175], v[100:107], v4
    s_setprio 2
    v_exp_f32 v124, v124
    v_exp_f32 v125, v125
    v_exp_f32 v126, v126
    v_exp_f32 v127, v127
    v_smfmac_f32_32x32x32_bf16 v[36:51], v[176:179], v[108:115], v4
    v_exp_f32 v128, v128
    v_exp_f32 v129, v129
    v_exp_f32 v130, v130
    v_exp_f32 v131, v131
    s_waitcnt lgkmcnt(0)
    v_smfmac_f32_32x32x32_bf16 v[52:67], v[164:167], v[116:123], v4
    v_exp_f32 v132, v132
    v_exp_f32 v133, v133
    v_exp_f32 v134, v134
    v_exp_f32 v135, v135
    v_exp_f32 v136, v136
    v_exp_f32 v137, v137
    v_exp_f32 v138, v138
    v_exp_f32 v139, v139
    v_smfmac_f32_32x32x32_bf16 v[52:67], v[168:171], v[124:131], v4
    ds_write_b128 v12, v[36:39] offset:0
    ds_write_b128 v12, v[40:43] offset:1024
    ds_write_b128 v12, v[44:47] offset:2048
    ds_write_b128 v12, v[48:51] offset:3072
    ds_write_b32 v29, v9
    s_setprio 1
    v_exp_f32 v140, v140
    v_exp_f32 v141, v141
    v_exp_f32 v142, v142
    v_exp_f32 v143, v143
    v_exp_f32 v144, v144
    v_exp_f32 v145, v145
    v_exp_f32 v146, v146
    v_exp_f32 v147, v147
    s_nop 0
    v_smfmac_f32_32x32x32_bf16 v[52:67], v[172:175], v[132:139], v4
    v_smfmac_f32_32x32x32_bf16 v[52:67], v[176:179], v[140:147], v4
    s_mov_b32 s75, 0x400000
L_mwait:
    ds_read_b32 v7, v17
    ds_read_b128 v[96:99], v13 offset:3072
    ds_read_b128 v[84:87], v13 offset:0
    ds_read_b128 v[88:91], v13 offset:1024
    ds_read_b128 v[92:95], v13 offset:2048
    s_sub_u32 s75, s75, 1
    s_cbranch_scc1 L_mgo
    s_waitcnt lgkmcnt(4)
    v_readfirstlane_b32 s60, v7
    s_nop 0
    s_cmp_eq_u32 s60, 0
    s_cbranch_scc1 L_mspin
L_mgo:
    s_waitcnt lgkmcnt(3)
    s_nop 1
    s_nop 0
    v_pk_add_f32 v[64:65], v[64:65], v[96:97]
    v_pk_add_f32 v[66:67], v[66:67], v[98:99]
L_norm:
    v_mov_b32 v5, v64
    v_mov_b32 v34, v64
    s_waitcnt lgkmcnt(0)
    v_pk_add_f32 v[52:53], v[52:53], v[84:85]
    v_permlane32_swap_b32 v5, v34
    v_pk_add_f32 v[54:55], v[54:55], v[86:87]
    v_subrev_u32 v5, 0x27800000, v34
    v_rcp_f32 v34, v34
    v_cmp_lt_u32 vcc, s89, v5
    v_pk_add_f32 v[56:57], v[56:57], v[88:89]
    v_pk_add_f32 v[58:59], v[58:59], v[90:91]
    v_pk_add_f32 v[60:61], v[60:61], v[92:93]
    v_pk_add_f32 v[62:63], v[62:63], v[94:95]
    s_cmp_lg_u64 vcc, 0
    s_cbranch_scc1 L_slow
    v_pk_mul_f32 v[52:53], v[52:53], v[34:35] op_sel_hi:[1,0]
    v_pk_mul_f32 v[54:55], v[54:55], v[34:35] op_sel_hi:[1,0]
    v_pk_mul_f32 v[56:57], v[56:57], v[34:35] op_sel_hi:[1,0]
    v_pk_mul_f32 v[58:59], v[58:59], v[34:35] op_sel_hi:[1,0]
    v_cvt_pk_bf16_f32 v180, v52, v53
    v_cvt_pk_bf16_f32 v181, v54, v55
    v_cvt_pk_bf16_f32 v182, v56, v57
    v_cvt_pk_bf16_f32 v183, v58, v59
    v_min_u32 v180, -2, v180
    v_min_u32 v181, -2, v181
    v_min_u32 v182, -2, v182
    v_min_u32 v183, -2, v183
    buffer_store_dwordx4 v[180:183], v3, s[36:39], s76 offen offset:0 sc1
    v_pk_mul_f32 v[60:61], v[60:61], v[34:35] op_sel_hi:[1,0]
    v_pk_mul_f32 v[62:63], v[62:63], v[34:35] op_sel_hi:[1,0]
    v_pk_mul_f32 v[64:65], v[64:65], v[34:35] op_sel_hi:[1,0]
    v_pk_mul_f32 v[66:67], v[66:67], v[34:35] op_sel_hi:[1,0]
    v_cvt_pk_bf16_f32 v184, v60, v61
    v_cvt_pk_bf16_f32 v185, v62, v63
    v_cvt_pk_bf16_f32 v186, v64, v65
    v_cvt_pk_bf16_f32 v187, v66, v67
    v_cndmask_b32 v186, 0, v186, s[64:65]
    v_cndmask_b32 v187, 0, v187, s[64:65]
    v_min_u32 v184, -2, v184
    v_min_u32 v185, -2, v185
    v_min_u32 v186, -2, v186
    v_min_u32 v187, -2, v187
    buffer_store_dwordx4 v[184:187], v3, s[36:39], s76 offen offset:1024 sc1
    s_setprio 0
L_p3e:
    s_mov_b32 s75, 0x40000
    s_add_u32 s14, s86, 0
    s_add_u32 s15, s86, 4096
    s_add_u32 s16, s86, 8192
    s_add_u32 s17, s86, 12288
    s_add_u32 s18, s86, 16384
    s_add_u32 s19, s86, 20480
    s_add_u32 s20, s86, 24576
    s_add_u32 s21, s86, 28672
L_p3r:
    s_mov_b32 s85, 0
    v_add_u32 v6, 75264, v21
    v_add_u32 v7, 75264, v22
    v_add_u32 v8, s13, v21
    v_add_u32 v9, s13, v22
    s_waitcnt lgkmcnt(0)
    ds_read_b64_tr_b16 v[36:37], v21 offset:0
    ds_read_b64_tr_b16 v[38:39], v22 offset:0
    ds_read_b64_tr_b16 v[40:41], v21 offset:32
    ds_read_b64_tr_b16 v[42:43], v22 offset:32
    ds_read_b64_tr_b16 v[44:45], v21 offset:64
    ds_read_b64_tr_b16 v[46:47], v22 offset:64
    ds_read_b64_tr_b16 v[48:49], v21 offset:96
    ds_read_b64_tr_b16 v[50:51], v22 offset:96
    ds_read_b64_tr_b16 v[52:53], v21 offset:128
    ds_read_b64_tr_b16 v[54:55], v22 offset:128
    ds_read_b64_tr_b16 v[56:57], v21 offset:160
    ds_read_b64_tr_b16 v[58:59], v22 offset:160
    s_waitcnt lgkmcnt(8)
    ds_read_b64_tr_b16 v[60:61], v21 offset:192
    ds_read_b64_tr_b16 v[62:63], v22 offset:192
    ds_read_b64_tr_b16 v[64:65], v21 offset:12544
    ds_read_b64_tr_b16 v[66:67], v22 offset:12544
    ds_read_b64_tr_b16 v[68:69], v21 offset:12576
    ds_read_b64_tr_b16 v[70:71], v22 offset:12576
    s_waitcnt lgkmcnt(8)
    ds_read_b64_tr_b16 v[72:73], v21 offset:12608
    ds_read_b64_tr_b16 v[74:75], v22 offset:12608
    ds_read_b64_tr_b16 v[76:77], v21 offset:12640
    ds_read_b64_tr_b16 v[78:79], v22 offset:12640
    ds_read_b64_tr_b16 v[80:81], v21 offset:12672
    ds_read_b64_tr_b16 v[82:83], v22 offset:12672
    s_waitcnt lgkmcnt(8)
    ds_read_b64_tr_b16 v[84:85], v21 offset:12704
    ds_read_b64_tr_b16 v[86:87], v22 offset:12704
    ds_read_b64_tr_b16 v[88:89], v21 offset:12736
    ds_read_b64_tr_b16 v[90:91], v22 offset:12736
    ds_read_b64_tr_b16 v[92:93], v21 offset:25088
    ds_read_b64_tr_b16 v[94:95], v22 offset:25088
    s_waitcnt lgkmcnt(8)
    ds_read_b64_tr_b16 v[96:97], v21 offset:25120
    ds_read_b64_tr_b16 v[98:99], v22 offset:25120
    ds_read_b64_tr_b16 v[100:101], v21 offset:25152
    ds_read_b64_tr_b16 v[102:103], v22 offset:25152
    ds_read_b64_tr_b16 v[104:105], v21 offset:25184
    ds_read_b64_tr_b16 v[106:107], v22 offset:25184
    s_waitcnt lgkmcnt(8)
    ds_read_b64_tr_b16 v[108:109], v21 offset:25216
    ds_read_b64_tr_b16 v[110:111], v22 offset:25216
    ds_read_b64_tr_b16 v[112:113], v21 offset:25248
    ds_read_b64_tr_b16 v[114:115], v22 offset:25248
    ds_read_b64_tr_b16 v[116:117], v21 offset:25280
    ds_read_b64_tr_b16 v[118:119], v22 offset:25280
    s_waitcnt lgkmcnt(8)
    ds_read_b64_tr_b16 v[120:121], v21 offset:37632
    ds_read_b64_tr_b16 v[122:123], v22 offset:37632
    ds_read_b64_tr_b16 v[124:125], v21 offset:37664
    ds_read_b64_tr_b16 v[126:127], v22 offset:37664
    ds_read_b64_tr_b16 v[128:129], v21 offset:37696
    ds_read_b64_tr_b16 v[130:131], v22 offset:37696
    s_waitcnt lgkmcnt(8)
    ds_read_b64_tr_b16 v[132:133], v21 offset:37728
    ds_read_b64_tr_b16 v[134:135], v22 offset:37728
    ds_read_b64_tr_b16 v[136:137], v21 offset:37760
    ds_read_b64_tr_b16 v[138:139], v22 offset:37760
    ds_read_b64_tr_b16 v[140:141], v21 offset:37792
    ds_read_b64_tr_b16 v[142:143], v22 offset:37792
    s_waitcnt lgkmcnt(8)
    ds_read_b64_tr_b16 v[144:145], v21 offset:37824
    ds_read_b64_tr_b16 v[146:147], v22 offset:37824
    ds_read_b64_tr_b16 v[148:149], v21 offset:50176
    ds_read_b64_tr_b16 v[150:151], v22 offset:50176
    ds_read_b64_tr_b16 v[152:153], v21 offset:50208
    ds_read_b64_tr_b16 v[154:155], v22 offset:50208
    s_waitcnt lgkmcnt(8)
    ds_read_b64_tr_b16 v[156:157], v21 offset:50240
    ds_read_b64_tr_b16 v[158:159], v22 offset:50240
    ds_read_b64_tr_b16 v[160:161], v21 offset:50272
    ds_read_b64_tr_b16 v[162:163], v22 offset:50272
    ds_read_b64_tr_b16 v[164:165], v21 offset:50304
    ds_read_b64_tr_b16 v[166:167], v22 offset:50304
    s_waitcnt lgkmcnt(8)
    ds_read_b64_tr_b16 v[168:169], v21 offset:50336
    ds_read_b64_tr_b16 v[170:171], v22 offset:50336
    ds_read_b64_tr_b16 v[172:173], v21 offset:50368
    ds_read_b64_tr_b16 v[174:175], v22 offset:50368
    ds_read_b64_tr_b16 v[176:177], v21 offset:62720
    ds_read_b64_tr_b16 v[178:179], v22 offset:62720
    s_waitcnt lgkmcnt(8)
    ds_read_b64_tr_b16 v[180:181], v21 offset:62752
    ds_read_b64_tr_b16 v[182:183], v22 offset:62752
    ds_read_b64_tr_b16 v[184:185], v21 offset:62784
    ds_read_b64_tr_b16 v[186:187], v22 offset:62784
    ds_read_b64_tr_b16 v[188:189], v21 offset:62816
    ds_read_b64_tr_b16 v[190:191], v22 offset:62816
    s_waitcnt lgkmcnt(8)
    ds_read_b64_tr_b16 v[192:193], v21 offset:62848
    ds_read_b64_tr_b16 v[194:195], v22 offset:62848
    ds_read_b64_tr_b16 v[12:13], v21 offset:62880
    ds_read_b64_tr_b16 v[14:15], v22 offset:62880
    s_andn2_b32 exec_lo, 0xff, s85
    s_mov_b32 exec_hi, 0
    buffer_load_dword v11, v30, s[36:39], s86 offen sc1
    s_mov_b64 exec, -1
    ds_read_b64_tr_b16 v[16:17], v21 offset:62912
    ds_read_b64_tr_b16 v[18:19], v22 offset:62912
    s_branch L_w1
L_w0:
    s_andn2_b32 exec_lo, 0xff, s85
    s_mov_b32 exec_hi, 0
    buffer_load_dword v11, v30, s[36:39], s86 offen sc1
    s_mov_b64 exec, -1
L_w1:
    s_sub_u32 s75, s75, 1
    s_cselect_b32 s60, 0xff, 0
    s_cselect_b32 s75, 0, s75
    s_waitcnt vmcnt(0)
    v_cmp_ne_u32 vcc, -1, v11
    s_nop 0
    s_or_b32 s85, vcc_lo, s60
    s_andn2_b32 s60, 0xff, s85
    s_cbranch_scc1 L_w0
    buffer_load_dwordx4 v[196:199], v20, s[36:39], s14 offen sc1
    buffer_load_dwordx4 v[200:203], v20, s[36:39], s15 offen sc1
    buffer_load_dwordx4 v[204:207], v20, s[36:39], s16 offen sc1
    buffer_load_dwordx4 v[208:211], v20, s[36:39], s17 offen sc1
    buffer_load_dwordx4 v[212:215], v20, s[36:39], s18 offen sc1
    buffer_load_dwordx4 v[216:219], v20, s[36:39], s19 offen sc1
    buffer_load_dwordx4 v[220:223], v20, s[36:39], s20 offen sc1
    buffer_load_dwordx4 v[224:227], v20, s[36:39], s21 offen sc1
    v_mov_b32 v34, 1
    s_add_u32 s61, s88, 14336
    v_xor_b32 v1, 32, v26
    v_xor_b32 v4, 64, v26
    v_xor_b32 v10, 96, v26
    s_cmp_eq_u32 s78, 0
    s_cbranch_scc1 L_x0
    s_setprio 1
    s_waitcnt vmcnt(7) lgkmcnt(0)
    v_mfma_f32_16x16x32_bf16 v[228:231], v[36:39], v[196:199], 0
    ds_read_b64_tr_b16 v[36:37], v6 offset:0
    ds_read_b64_tr_b16 v[38:39], v7 offset:0
    v_max3_u32 v5, v196, v197, 0
    v_mfma_f32_16x16x32_bf16 v[232:235], v[40:43], v[196:199], 0
    ds_read_b64_tr_b16 v[40:41], v6 offset:32
    ds_read_b64_tr_b16 v[42:43], v7 offset:32
    v_max3_u32 v5, v198, v199, v5
    v_mfma_f32_16x16x32_bf16 v[236:239], v[44:47], v[196:199], 0
    ds_read_b64_tr_b16 v[44:45], v6 offset:64
    ds_read_b64_tr_b16 v[46:47], v7 offset:64
    v_mfma_f32_16x16x32_bf16 v[240:243], v[48:51], v[196:199], 0
    ds_read_b64_tr_b16 v[48:49], v6 offset:96
    ds_read_b64_tr_b16 v[50:51], v7 offset:96
    v_mfma_f32_16x16x32_bf16 v[244:247], v[52:55], v[196:199], 0
    ds_read_b64_tr_b16 v[52:53], v6 offset:128
    ds_read_b64_tr_b16 v[54:55], v7 offset:128
    v_mfma_f32_16x16x32_bf16 v[248:251], v[56:59], v[196:199], 0
    ds_read_b64_tr_b16 v[56:57], v6 offset:160
    ds_read_b64_tr_b16 v[58:59], v7 offset:160
    v_mfma_f32_16x16x32_bf16 v[252:255], v[60:63], v[196:199], 0
    ds_read_b64_tr_b16 v[60:61], v6 offset:192
    ds_read_b64_tr_b16 v[62:63], v7 offset:192
    s_waitcnt vmcnt(6)
    v_mfma_f32_16x16x32_bf16 v[228:231], v[64:67], v[200:203], v[228:231]
    ds_read_b64_tr_b16 v[64:65], v8 offset:0
    s_waitcnt lgkmcnt(11)
    ds_read_b64_tr_b16 v[66:67], v9 offset:0
    v_max3_u32 v5, v200, v201, v5
    v_mfma_f32_16x16x32_bf16 v[232:235], v[68:71], v[200:203], v[232:235]
    ds_read_b64_tr_b16 v[68:69], v8 offset:32
    ds_read_b64_tr_b16 v[70:71], v9 offset:32
    v_max3_u32 v5, v202, v203, v5
    v_mfma_f32_16x16x32_bf16 v[236:239], v[72:75], v[200:203], v[236:239]
    ds_read_b64_tr_b16 v[72:73], v8 offset:64
    s_waitcnt lgkmcnt(11)
    ds_read_b64_tr_b16 v[74:75], v9 offset:64
    v_mfma_f32_16x16x32_bf16 v[240:243], v[76:79], v[200:203], v[240:243]
    ds_read_b64_tr_b16 v[76:77], v8 offset:96
    ds_read_b64_tr_b16 v[78:79], v9 offset:96
    v_mfma_f32_16x16x32_bf16 v[244:247], v[80:83], v[200:203], v[244:247]
    ds_read_b64_tr_b16 v[80:81], v8 offset:128
    s_waitcnt lgkmcnt(11)
    ds_read_b64_tr_b16 v[82:83], v9 offset:128
    v_mfma_f32_16x16x32_bf16 v[248:251], v[84:87], v[200:203], v[248:251]
    ds_read_b64_tr_b16 v[84:85], v8 offset:160
    ds_read_b64_tr_b16 v[86:87], v9 offset:160
    v_mfma_f32_16x16x32_bf16 v[252:255], v[88:91], v[200:203], v[252:255]
    ds_read_b64_tr_b16 v[88:89], v8 offset:192
    s_waitcnt lgkmcnt(11)
    ds_read_b64_tr_b16 v[90:91], v9 offset:192
    s_waitcnt vmcnt(5)
    v_mfma_f32_16x16x32_bf16 v[228:231], v[92:95], v[204:207], v[228:231]
    v_max3_u32 v5, v204, v205, v5
    v_mfma_f32_16x16x32_bf16 v[232:235], v[96:99], v[204:207], v[232:235]
    v_max3_u32 v5, v206, v207, v5
    v_mfma_f32_16x16x32_bf16 v[236:239], v[100:103], v[204:207], v[236:239]
    v_mfma_f32_16x16x32_bf16 v[240:243], v[104:107], v[204:207], v[240:243]
    s_waitcnt vmcnt(4)
    v_mfma_f32_16x16x32_bf16 v[228:231], v[120:123], v[208:211], v[228:231]
    v_max3_u32 v5, v208, v209, v5
    v_mfma_f32_16x16x32_bf16 v[232:235], v[124:127], v[208:211], v[232:235]
    v_max3_u32 v5, v210, v211, v5
    v_mfma_f32_16x16x32_bf16 v[236:239], v[128:131], v[208:211], v[236:239]
    v_mfma_f32_16x16x32_bf16 v[240:243], v[132:135], v[208:211], v[240:243]
    s_waitcnt vmcnt(3)
    v_mfma_f32_16x16x32_bf16 v[228:231], v[148:151], v[212:215], v[228:231]
    v_max3_u32 v5, v212, v213, v5
    v_mfma_f32_16x16x32_bf16 v[232:235], v[152:155], v[212:215], v[232:235]
    v_max3_u32 v5, v214, v215, v5
    v_mfma_f32_16x16x32_bf16 v[236:239], v[156:159], v[212:215], v[236:239]
    v_mfma_f32_16x16x32_bf16 v[240:243], v[160:163], v[212:215], v[240:243]
    s_waitcnt vmcnt(2)
    v_mfma_f32_16x16x32_bf16 v[228:231], v[176:179], v[216:219], v[228:231]
    v_max3_u32 v5, v216, v217, v5
    v_mfma_f32_16x16x32_bf16 v[232:235], v[180:183], v[216:219], v[232:235]
    v_max3_u32 v5, v218, v219, v5
    v_mfma_f32_16x16x32_bf16 v[236:239], v[184:187], v[216:219], v[236:239]
    v_mfma_f32_16x16x32_bf16 v[240:243], v[188:191], v[216:219], v[240:243]
    s_waitcnt vmcnt(1)
    v_mfma_f32_16x16x32_bf16 v[228:231], v[36:39], v[220:223], v[228:231]
    v_max3_u32 v5, v220, v221, v5
    v_mfma_f32_16x16x32_bf16 v[232:235], v[40:43], v[220:223], v[232:235]
    v_max3_u32 v5, v222, v223, v5
    v_mfma_f32_16x16x32_bf16 v[236:239], v[44:47], v[220:223], v[236:239]
    v_mfma_f32_16x16x32_bf16 v[240:243], v[48:51], v[220:223], v[240:243]
    s_waitcnt vmcnt(0)
    v_mfma_f32_16x16x32_bf16 v[228:231], v[64:67], v[224:227], v[228:231]
    v_max3_u32 v5, v224, v225, v5
    s_waitcnt lgkmcnt(10)
    v_mfma_f32_16x16x32_bf16 v[232:235], v[68:71], v[224:227], v[232:235]
    v_max3_u32 v5, v226, v227, v5
    s_waitcnt lgkmcnt(8)
    v_mfma_f32_16x16x32_bf16 v[236:239], v[72:75], v[224:227], v[236:239]
    s_waitcnt lgkmcnt(6)
    v_mfma_f32_16x16x32_bf16 v[240:243], v[76:79], v[224:227], v[240:243]
    v_cmp_eq_u32 vcc, -1, v5
    v_mfma_f32_16x16x32_bf16 v[244:247], v[108:111], v[204:207], v[244:247]
    s_cmp_lg_u64 vcc, 0
    s_cbranch_scc1 L_redok1
L_goodk1:
    v_mfma_f32_16x16x32_bf16 v[248:251], v[112:115], v[204:207], v[248:251]
    v_mfma_f32_16x16x32_bf16 v[252:255], v[116:119], v[204:207], v[252:255]
    ds_write_b128 v24, v[228:231] offset:0
    v_mfma_f32_16x16x32_bf16 v[244:247], v[136:139], v[208:211], v[244:247]
    ds_write_b128 v24, v[232:235] offset:1024
    v_mfma_f32_16x16x32_bf16 v[248:251], v[140:143], v[208:211], v[248:251]
    ds_write_b128 v24, v[236:239] offset:2048
    v_mfma_f32_16x16x32_bf16 v[252:255], v[144:147], v[208:211], v[252:255]
    ds_write_b128 v24, v[240:243] offset:3072
    v_mfma_f32_16x16x32_bf16 v[244:247], v[164:167], v[212:215], v[244:247]
    ds_write_b32 v25, v34 offset:32
    s_setprio 0
    v_mfma_f32_16x16x32_bf16 v[248:251], v[168:171], v[212:215], v[248:251]
    v_mfma_f32_16x16x32_bf16 v[252:255], v[172:175], v[212:215], v[252:255]
    v_mfma_f32_16x16x32_bf16 v[244:247], v[192:195], v[216:219], v[244:247]
    v_mfma_f32_16x16x32_bf16 v[248:251], v[12:15], v[216:219], v[248:251]
    v_mfma_f32_16x16x32_bf16 v[252:255], v[16:19], v[216:219], v[252:255]
    v_mfma_f32_16x16x32_bf16 v[244:247], v[52:55], v[220:223], v[244:247]
    v_mfma_f32_16x16x32_bf16 v[248:251], v[56:59], v[220:223], v[248:251]
    v_mfma_f32_16x16x32_bf16 v[252:255], v[60:63], v[220:223], v[252:255]
    s_waitcnt lgkmcnt(9)
    v_mfma_f32_16x16x32_bf16 v[244:247], v[80:83], v[224:227], v[244:247]
    ds_read_b32 v5, v25 offset:16
    ds_read_b128 v[92:95], v23 offset:0
    s_waitcnt lgkmcnt(9)
    v_mfma_f32_16x16x32_bf16 v[248:251], v[84:87], v[224:227], v[248:251]
    ds_read_b128 v[120:123], v23 offset:1024
    s_waitcnt lgkmcnt(8)
    v_mfma_f32_16x16x32_bf16 v[252:255], v[88:91], v[224:227], v[252:255]
    ds_read_b128 v[148:151], v23 offset:2048
    s_mov_b32 s75, 0x400000
    s_waitcnt lgkmcnt(3)
    v_readfirstlane_b32 s60, v5
    s_nop 0
    s_cmp_eq_u32 s60, 0
    s_cbranch_scc1 L_xsk1
L_yk1:
    s_waitcnt lgkmcnt(2)
    v_pk_add_f32 v[244:245], v[244:245], v[92:93]
    v_pk_add_f32 v[246:247], v[246:247], v[94:95]
    v_cvt_pk_bf16_f32 v196, v244, v245
    v_cvt_pk_bf16_f32 v197, v246, v247
    ds_write_b64 v26, v[196:197]
    s_waitcnt lgkmcnt(2)
    v_pk_add_f32 v[248:249], v[248:249], v[120:121]
    v_pk_add_f32 v[250:251], v[250:251], v[122:123]
    v_cvt_pk_bf16_f32 v198, v248, v249
    v_cvt_pk_bf16_f32 v199, v250, v251
    ds_write_b64 v1, v[198:199]
    s_waitcnt lgkmcnt(2)
    v_pk_add_f32 v[252:253], v[252:253], v[148:149]
    v_pk_add_f32 v[254:255], v[254:255], v[150:151]
    v_cvt_pk_bf16_f32 v200, v252, v253
    v_cvt_pk_bf16_f32 v201, v254, v255
    ds_write_b64 v4, v[200:201]
    ds_read_b128 v[204:207], v27
    ds_read_b128 v[208:211], v27 offset:1024
    s_waitcnt lgkmcnt(1)
    buffer_store_dwordx4 v[204:207], v28, s[44:47], s88 offen sc1
    s_waitcnt lgkmcnt(0)
    buffer_store_dwordx4 v[208:211], v28, s[44:47], s61 offen sc1
    s_endpgm
L_xsk1:
    ds_read_b32 v5, v25 offset:16
    s_sub_u32 s75, s75, 1
    s_waitcnt lgkmcnt(0)
    s_cbranch_scc1 L_yk1
    v_readfirstlane_b32 s60, v5
    s_nop 0
    s_cmp_eq_u32 s60, 0
    s_cbranch_scc1 L_xsk1
    ds_read_b128 v[92:95], v23 offset:0
    ds_read_b128 v[120:123], v23 offset:1024
    ds_read_b128 v[148:151], v23 offset:2048
    s_branch L_yk1
L_mspin:
    ds_read_b32 v7, v17
    s_sub_u32 s75, s75, 1
    s_waitcnt lgkmcnt(0)
    s_cbranch_scc1 L_mgo
    v_readfirstlane_b32 s60, v7
    s_nop 0
    s_cmp_eq_u32 s60, 0
    s_cbranch_scc1 L_mspin
    s_branch L_mwait
L_x0:
    s_setprio 1
    s_waitcnt vmcnt(7) lgkmcnt(0)
    v_mfma_f32_16x16x32_bf16 v[244:247], v[52:55], v[196:199], 0
    ds_read_b64_tr_b16 v[52:53], v6 offset:128
    ds_read_b64_tr_b16 v[54:55], v7 offset:128
    v_max3_u32 v5, v196, v197, 0
    v_mfma_f32_16x16x32_bf16 v[248:251], v[56:59], v[196:199], 0
    ds_read_b64_tr_b16 v[56:57], v6 offset:160
    ds_read_b64_tr_b16 v[58:59], v7 offset:160
    v_max3_u32 v5, v198, v199, v5
    v_mfma_f32_16x16x32_bf16 v[252:255], v[60:63], v[196:199], 0
    ds_read_b64_tr_b16 v[60:61], v6 offset:192
    ds_read_b64_tr_b16 v[62:63], v7 offset:192
    v_mfma_f32_16x16x32_bf16 v[228:231], v[36:39], v[196:199], 0
    ds_read_b64_tr_b16 v[36:37], v6 offset:0
    ds_read_b64_tr_b16 v[38:39], v7 offset:0
    v_mfma_f32_16x16x32_bf16 v[232:235], v[40:43], v[196:199], 0
    ds_read_b64_tr_b16 v[40:41], v6 offset:32
    ds_read_b64_tr_b16 v[42:43], v7 offset:32
    v_mfma_f32_16x16x32_bf16 v[236:239], v[44:47], v[196:199], 0
    ds_read_b64_tr_b16 v[44:45], v6 offset:64
    ds_read_b64_tr_b16 v[46:47], v7 offset:64
    v_mfma_f32_16x16x32_bf16 v[240:243], v[48:51], v[196:199], 0
    ds_read_b64_tr_b16 v[48:49], v6 offset:96
    ds_read_b64_tr_b16 v[50:51], v7 offset:96
    s_waitcnt vmcnt(6)
    v_mfma_f32_16x16x32_bf16 v[244:247], v[80:83], v[200:203], v[244:247]
    ds_read_b64_tr_b16 v[80:81], v8 offset:128
    s_waitcnt lgkmcnt(11)
    ds_read_b64_tr_b16 v[82:83], v9 offset:128
    v_max3_u32 v5, v200, v201, v5
    v_mfma_f32_16x16x32_bf16 v[248:251], v[84:87], v[200:203], v[248:251]
    ds_read_b64_tr_b16 v[84:85], v8 offset:160
    ds_read_b64_tr_b16 v[86:87], v9 offset:160
    v_max3_u32 v5, v202, v203, v5
    v_mfma_f32_16x16x32_bf16 v[252:255], v[88:91], v[200:203], v[252:255]
    ds_read_b64_tr_b16 v[88:89], v8 offset:192
    s_waitcnt lgkmcnt(11)
    ds_read_b64_tr_b16 v[90:91], v9 offset:192
    v_mfma_f32_16x16x32_bf16 v[228:231], v[64:67], v[200:203], v[228:231]
    ds_read_b64_tr_b16 v[64:65], v8 offset:0
    ds_read_b64_tr_b16 v[66:67], v9 offset:0
    v_mfma_f32_16x16x32_bf16 v[232:235], v[68:71], v[200:203], v[232:235]
    ds_read_b64_tr_b16 v[68:69], v8 offset:32
    s_waitcnt lgkmcnt(11)
    ds_read_b64_tr_b16 v[70:71], v9 offset:32
    v_mfma_f32_16x16x32_bf16 v[236:239], v[72:75], v[200:203], v[236:239]
    ds_read_b64_tr_b16 v[72:73], v8 offset:64
    ds_read_b64_tr_b16 v[74:75], v9 offset:64
    v_mfma_f32_16x16x32_bf16 v[240:243], v[76:79], v[200:203], v[240:243]
    ds_read_b64_tr_b16 v[76:77], v8 offset:96
    s_waitcnt lgkmcnt(11)
    ds_read_b64_tr_b16 v[78:79], v9 offset:96
    s_waitcnt vmcnt(5)
    v_mfma_f32_16x16x32_bf16 v[244:247], v[108:111], v[204:207], v[244:247]
    v_max3_u32 v5, v204, v205, v5
    v_mfma_f32_16x16x32_bf16 v[248:251], v[112:115], v[204:207], v[248:251]
    v_max3_u32 v5, v206, v207, v5
    v_mfma_f32_16x16x32_bf16 v[252:255], v[116:119], v[204:207], v[252:255]
    s_waitcnt vmcnt(4)
    v_mfma_f32_16x16x32_bf16 v[244:247], v[136:139], v[208:211], v[244:247]
    v_max3_u32 v5, v208, v209, v5
    v_mfma_f32_16x16x32_bf16 v[248:251], v[140:143], v[208:211], v[248:251]
    v_max3_u32 v5, v210, v211, v5
    v_mfma_f32_16x16x32_bf16 v[252:255], v[144:147], v[208:211], v[252:255]
    s_waitcnt vmcnt(3)
    v_mfma_f32_16x16x32_bf16 v[244:247], v[164:167], v[212:215], v[244:247]
    v_max3_u32 v5, v212, v213, v5
    v_mfma_f32_16x16x32_bf16 v[248:251], v[168:171], v[212:215], v[248:251]
    v_max3_u32 v5, v214, v215, v5
    v_mfma_f32_16x16x32_bf16 v[252:255], v[172:175], v[212:215], v[252:255]
    s_waitcnt vmcnt(2)
    v_mfma_f32_16x16x32_bf16 v[244:247], v[192:195], v[216:219], v[244:247]
    v_max3_u32 v5, v216, v217, v5
    v_mfma_f32_16x16x32_bf16 v[248:251], v[12:15], v[216:219], v[248:251]
    v_max3_u32 v5, v218, v219, v5
    v_mfma_f32_16x16x32_bf16 v[252:255], v[16:19], v[216:219], v[252:255]
    s_waitcnt vmcnt(1)
    v_mfma_f32_16x16x32_bf16 v[244:247], v[52:55], v[220:223], v[244:247]
    v_max3_u32 v5, v220, v221, v5
    v_mfma_f32_16x16x32_bf16 v[248:251], v[56:59], v[220:223], v[248:251]
    v_max3_u32 v5, v222, v223, v5
    v_mfma_f32_16x16x32_bf16 v[252:255], v[60:63], v[220:223], v[252:255]
    s_waitcnt vmcnt(0)
    v_mfma_f32_16x16x32_bf16 v[244:247], v[80:83], v[224:227], v[244:247]
    v_max3_u32 v5, v224, v225, v5
    s_waitcnt lgkmcnt(10)
    v_mfma_f32_16x16x32_bf16 v[248:251], v[84:87], v[224:227], v[248:251]
    v_max3_u32 v5, v226, v227, v5
    s_waitcnt lgkmcnt(8)
    v_mfma_f32_16x16x32_bf16 v[252:255], v[88:91], v[224:227], v[252:255]
    v_cmp_eq_u32 vcc, -1, v5
    v_mfma_f32_16x16x32_bf16 v[228:231], v[92:95], v[204:207], v[228:231]
    s_cmp_lg_u64 vcc, 0
    s_cbranch_scc1 L_redok0
L_goodk0:
    v_mfma_f32_16x16x32_bf16 v[232:235], v[96:99], v[204:207], v[232:235]
    v_mfma_f32_16x16x32_bf16 v[236:239], v[100:103], v[204:207], v[236:239]
    ds_write_b128 v23, v[244:247] offset:0
    v_mfma_f32_16x16x32_bf16 v[240:243], v[104:107], v[204:207], v[240:243]
    ds_write_b128 v23, v[248:251] offset:1024
    v_mfma_f32_16x16x32_bf16 v[228:231], v[120:123], v[208:211], v[228:231]
    ds_write_b128 v23, v[252:255] offset:2048
    v_mfma_f32_16x16x32_bf16 v[232:235], v[124:127], v[208:211], v[232:235]
    ds_write_b32 v25, v34 offset:16
    s_setprio 0
    v_mfma_f32_16x16x32_bf16 v[236:239], v[128:131], v[208:211], v[236:239]
    v_mfma_f32_16x16x32_bf16 v[240:243], v[132:135], v[208:211], v[240:243]
    v_mfma_f32_16x16x32_bf16 v[228:231], v[148:151], v[212:215], v[228:231]
    v_mfma_f32_16x16x32_bf16 v[232:235], v[152:155], v[212:215], v[232:235]
    v_mfma_f32_16x16x32_bf16 v[236:239], v[156:159], v[212:215], v[236:239]
    v_mfma_f32_16x16x32_bf16 v[240:243], v[160:163], v[212:215], v[240:243]
    v_mfma_f32_16x16x32_bf16 v[228:231], v[176:179], v[216:219], v[228:231]
    v_mfma_f32_16x16x32_bf16 v[232:235], v[180:183], v[216:219], v[232:235]
    v_mfma_f32_16x16x32_bf16 v[236:239], v[184:187], v[216:219], v[236:239]
    v_mfma_f32_16x16x32_bf16 v[240:243], v[188:191], v[216:219], v[240:243]
    v_mfma_f32_16x16x32_bf16 v[228:231], v[36:39], v[220:223], v[228:231]
    v_mfma_f32_16x16x32_bf16 v[232:235], v[40:43], v[220:223], v[232:235]
    v_mfma_f32_16x16x32_bf16 v[236:239], v[44:47], v[220:223], v[236:239]
    v_mfma_f32_16x16x32_bf16 v[240:243], v[48:51], v[220:223], v[240:243]
    s_waitcnt lgkmcnt(10)
    v_mfma_f32_16x16x32_bf16 v[228:231], v[64:67], v[224:227], v[228:231]
    ds_read_b32 v5, v25 offset:32
    ds_read_b128 v[108:111], v24 offset:0
    s_waitcnt lgkmcnt(10)
    v_mfma_f32_16x16x32_bf16 v[232:235], v[68:71], v[224:227], v[232:235]
    ds_read_b128 v[136:139], v24 offset:1024
    s_waitcnt lgkmcnt(9)
    v_mfma_f32_16x16x32_bf16 v[236:239], v[72:75], v[224:227], v[236:239]
    ds_read_b128 v[164:167], v24 offset:2048
    ds_read_b128 v[192:195], v24 offset:3072
    s_waitcnt lgkmcnt(9)
    v_mfma_f32_16x16x32_bf16 v[240:243], v[76:79], v[224:227], v[240:243]
    s_mov_b32 s75, 0x400000
    s_waitcnt lgkmcnt(4)
    v_readfirstlane_b32 s60, v5
    s_nop 0
    s_cmp_eq_u32 s60, 0
    s_cbranch_scc1 L_xsk0
L_yk0:
    s_waitcnt lgkmcnt(3)
    v_pk_add_f32 v[228:229], v[228:229], v[108:109]
    v_pk_add_f32 v[230:231], v[230:231], v[110:111]
    v_cvt_pk_bf16_f32 v196, v228, v229
    v_cvt_pk_bf16_f32 v197, v230, v231
    ds_write_b64 v26, v[196:197]
    s_waitcnt lgkmcnt(3)
    v_pk_add_f32 v[232:233], v[232:233], v[136:137]
    v_pk_add_f32 v[234:235], v[234:235], v[138:139]
    v_cvt_pk_bf16_f32 v198, v232, v233
    v_cvt_pk_bf16_f32 v199, v234, v235
    ds_write_b64 v1, v[198:199]
    s_waitcnt lgkmcnt(3)
    v_pk_add_f32 v[236:237], v[236:237], v[164:165]
    v_pk_add_f32 v[238:239], v[238:239], v[166:167]
    v_cvt_pk_bf16_f32 v200, v236, v237
    v_cvt_pk_bf16_f32 v201, v238, v239
    ds_write_b64 v4, v[200:201]
    s_waitcnt lgkmcnt(3)
    v_pk_add_f32 v[240:241], v[240:241], v[192:193]
    v_pk_add_f32 v[242:243], v[242:243], v[194:195]
    v_cvt_pk_bf16_f32 v202, v240, v241
    v_cvt_pk_bf16_f32 v203, v242, v243
    ds_write_b64 v10, v[202:203]
    ds_read_b128 v[204:207], v27
    ds_read_b128 v[208:211], v27 offset:1024
    s_waitcnt lgkmcnt(1)
    buffer_store_dwordx4 v[204:207], v28, s[44:47], s88 offen sc1
    s_waitcnt lgkmcnt(0)
    buffer_store_dwordx4 v[208:211], v28, s[44:47], s61 offen sc1
    s_endpgm
L_xsk0:
    ds_read_b32 v5, v25 offset:32
    s_sub_u32 s75, s75, 1
    s_waitcnt lgkmcnt(0)
    s_cbranch_scc1 L_yk0
    v_readfirstlane_b32 s60, v5
    s_nop 0
    s_cmp_eq_u32 s60, 0
    s_cbranch_scc1 L_xsk0
    ds_read_b128 v[108:111], v24 offset:0
    ds_read_b128 v[136:139], v24 offset:1024
    ds_read_b128 v[164:167], v24 offset:2048
    ds_read_b128 v[192:195], v24 offset:3072
    s_branch L_yk0
L_noep:
L_end:
    s_endpgm
L_redok1:
    s_sub_u32 s75, s75, 1
    s_cbranch_scc0 L_p3r
    s_branch L_goodk1
L_redok0:
    s_sub_u32 s75, s75, 1
    s_cbranch_scc0 L_p3r
    s_branch L_goodk0
L_epoch:
    s_add_u32 s53, s53, 1
    s_lshl_b32 s60, s49, 8
    s_add_u32 s60, s60, 65536
    v_mov_b32 v6, s53
    s_mov_b64 exec, 1
    buffer_store_dword v6, v3, s[36:39], s60 offen sc1
    s_mov_b64 exec, -1
    s_branch L_epd
L_pollc:
    s_mov_b32 s75, 0x40000
L_pollc1:
    buffer_load_dword v11, v18, s[36:39], s87 offen sc1
    s_sub_u32 s75, s75, 1
    s_cbranch_scc1 L_pollc_done
    s_waitcnt vmcnt(0)
    v_cmp_ne_u32 vcc, s52, v11
    s_nop 0
    s_and_b32 s94, vcc_lo, 0xffff
    s_cbranch_scc1 L_pollc1
    s_branch L_pollc_done
L_polll:
    s_mov_b32 s75, 0x40000
L_polll1:
    s_mov_b64 exec, 0xffff
    buffer_load_dword v34, v17, s[36:39], s5 offen sc1
    s_mov_b64 exec, -1
    s_sub_u32 s75, s75, 1
    s_cbranch_scc1 L_polll_done
    s_waitcnt vmcnt(0)
    v_cmp_ne_u32 vcc, s52, v34
    s_nop 0
    s_and_b32 s94, vcc_lo, 0xffff
    s_cbranch_scc1 L_polll1
    s_branch L_polll_done
L_pollh:
    s_mov_b32 s75, 0x40000
L_pollh1:
    s_mov_b64 exec, 0xffff0000
    buffer_load_dword v34, v17, s[36:39], s5 offen sc1
    s_mov_b64 exec, -1
    s_sub_u32 s75, s75, 1
    s_cbranch_scc1 L_pollh_done
    s_waitcnt vmcnt(0)
    v_cmp_ne_u32 vcc, s52, v34
    s_nop 0
    s_and_b32 s94, vcc_lo, 0xffff0000
    s_cbranch_scc1 L_pollh1
    s_branch L_pollh_done
L_slow:
    s_mov_b32 s89, -1
    v_lshlrev_b32 v19, 3, v1
    v_mov_b32 v9, 0xff7fffff
    s_mov_b32 s60, s68
    s_mov_b32 s71, 0
    v_mov_b32 v52, 0
    v_mov_b32 v84, 0
    v_mov_b32 v53, 0
    v_mov_b32 v85, 0
    v_mov_b32 v54, 0
    v_mov_b32 v86, 0
    v_mov_b32 v55, 0
    v_mov_b32 v87, 0
    v_mov_b32 v56, 0
    v_mov_b32 v88, 0
    v_mov_b32 v57, 0
    v_mov_b32 v89, 0
    v_mov_b32 v58, 0
    v_mov_b32 v90, 0
    v_mov_b32 v59, 0
    v_mov_b32 v91, 0
    v_mov_b32 v60, 0
    v_mov_b32 v92, 0
    v_mov_b32 v61, 0
    v_mov_b32 v93, 0
    v_mov_b32 v62, 0
    v_mov_b32 v94, 0
    v_mov_b32 v63, 0
    v_mov_b32 v95, 0
    v_mov_b32 v64, 0
    v_mov_b32 v96, 0
    v_mov_b32 v65, 0
    v_mov_b32 v97, 0
    v_mov_b32 v66, 0
    v_mov_b32 v98, 0
    v_mov_b32 v67, 0
    v_mov_b32 v99, 0
L_slow_t:
    buffer_load_dwordx2 v[148:149], v19, s[36:39], s60 offen offset:0 sc1
    buffer_load_dwordx2 v[150:151], v19, s[36:39], s60 offen offset:512 sc1
    buffer_load_dwordx2 v[152:153], v19, s[36:39], s60 offen offset:1024 sc1
    buffer_load_dwordx2 v[154:155], v19, s[36:39], s60 offen offset:1536 sc1
    buffer_load_dwordx4 v[164:167], v3, s[36:39], s60 offen offset:2048 sc1
    buffer_load_dwordx4 v[168:171], v3, s[36:39], s60 offen offset:3072 sc1
    s_add_u32 s60, s60, 4096
    s_waitcnt vmcnt(0)
    v_mfma_f32_32x32x16_bf16 v[116:131], v[148:151], v[76:79], 0
    v_mfma_f32_32x32x16_bf16 v[116:131], v[152:155], v[80:83], v[116:131]
    s_nop 10
    s_nop 0
    v_max3_f32 v5, v116, v117, v9
    v_max3_f32 v5, v118, v119, v5
    v_max3_f32 v5, v120, v121, v5
    v_max3_f32 v5, v122, v123, v5
    v_max3_f32 v5, v124, v125, v5
    v_max3_f32 v5, v126, v127, v5
    v_max3_f32 v5, v128, v129, v5
    v_max3_f32 v5, v130, v131, v5
    v_mov_b32 v6, v5
    s_nop 0
    s_nop 0
    v_permlane32_swap_b32 v5, v6
    v_max_f32 v7, v5, v6
    v_sub_f32 v8, v9, v7
    v_exp_f32 v8, v8
    v_mov_b32 v9, v7
    v_sub_f32 v116, v116, v7
    v_sub_f32 v117, v117, v7
    v_sub_f32 v118, v118, v7
    v_sub_f32 v119, v119, v7
    v_sub_f32 v120, v120, v7
    v_sub_f32 v121, v121, v7
    v_sub_f32 v122, v122, v7
    v_sub_f32 v123, v123, v7
    v_sub_f32 v124, v124, v7
    v_sub_f32 v125, v125, v7
    v_sub_f32 v126, v126, v7
    v_sub_f32 v127, v127, v7
    v_sub_f32 v128, v128, v7
    v_sub_f32 v129, v129, v7
    v_sub_f32 v130, v130, v7
    v_sub_f32 v131, v131, v7
    v_exp_f32 v116, v116
    v_exp_f32 v117, v117
    v_exp_f32 v118, v118
    v_exp_f32 v119, v119
    v_exp_f32 v120, v120
    v_exp_f32 v121, v121
    v_exp_f32 v122, v122
    v_exp_f32 v123, v123
    v_exp_f32 v124, v124
    v_exp_f32 v125, v125
    v_exp_f32 v126, v126
    v_exp_f32 v127, v127
    v_exp_f32 v128, v128
    v_exp_f32 v129, v129
    v_exp_f32 v130, v130
    v_exp_f32 v131, v131
    v_mul_f32 v52, v8, v52
    v_mul_f32 v53, v8, v53
    v_mul_f32 v54, v8, v54
    v_mul_f32 v55, v8, v55
    v_mul_f32 v56, v8, v56
    v_mul_f32 v57, v8, v57
    v_mul_f32 v58, v8, v58
    v_mul_f32 v59, v8, v59
    v_mul_f32 v60, v8, v60
    v_mul_f32 v61, v8, v61
    v_mul_f32 v62, v8, v62
    v_mul_f32 v63, v8, v63
    v_mul_f32 v64, v8, v64
    v_mul_f32 v65, v8, v65
    v_mul_f32 v66, v8, v66
    v_mul_f32 v67, v8, v67
    s_nop 0
    s_nop 0
    v_smfmac_f32_32x32x32_bf16 v[52:67], v[164:167], v[116:123], v4
    v_smfmac_f32_32x32x32_bf16 v[52:67], v[168:171], v[124:131], v4
    s_add_u32 s71, s71, 1
    s_cmp_lt_u32 s71, 64
    s_cbranch_scc1 L_slow_t
    s_nop 11
    s_branch L_norm
.section .rodata,"a"
.p2align 6
.amdhsa_kernel concat_heads__softmax_full_mha__softmax_full_mha__prompt_kernel
  .amdhsa_next_free_vgpr 256
  .amdhsa_next_free_sgpr 102
  .amdhsa_accum_offset 256
  .amdhsa_group_segment_fixed_size 0
  .amdhsa_kernarg_size 72
  .amdhsa_user_sgpr_count 2
  .amdhsa_user_sgpr_kernarg_segment_ptr 1
  .amdhsa_system_sgpr_workgroup_id_x 1
.end_amdhsa_kernel
```
